```python
import torch

def _softmax(x, axis=-1):
    return torch.softmax(x, dim=axis)
def _gelu(x):
    return torch.nn.functional.gelu(x, approximate="tanh")
def _silu(x):
    return torch.nn.functional.silu(x)
def _sigmoid(x):
    return torch.sigmoid(x)
def _layernorm(x, axis=-1, eps=1e-5):
    m = x.mean(dim=axis, keepdim=True)
    v = x.var(dim=axis, keepdim=True, unbiased=False)
    return (x - m) / torch.sqrt(v + eps)
def _scatter_add(tgt, idx, src, axis=0):
    return tgt.clone().index_add_(axis, idx, src)
def _segment_sum(src, seg, n):
    out = torch.zeros((n,) + src.shape[1:], dtype=src.dtype)
    return out.index_add_(0, seg, src)
def _pad(x, pw):
    flat = tuple(v for pair in reversed(pw) for v in pair)
    return torch.nn.functional.pad(x, flat)

kernel_name = 'standalone__structured_sparse_n_m__ragged'

def setup_inputs():

    _w = (lambda a: (lambda t: t.to(torch.bfloat16) if t.is_floating_point() else t)(torch.as_tensor(a)))
    B, S, D = 4, 2048, 576
    assert D % 4 == 0, "d_model must be divisible by M=4 for 2:4 sparsity"
    return {
        "x": _w((lambda *s: torch.randn(*s, dtype=torch.bfloat16) * 0.05)(B, S, D)),
        "w": _w((lambda *s: torch.randn(*s, dtype=torch.bfloat16) * 0.05)(D, D)),
        "b": _w((lambda *s: torch.randn(*s, dtype=torch.bfloat16) * 0.05)(D)),
    }

def reference(x, w, b):
    B, S, D = x.shape
    N, M = 2, 4
    G = D // M
    wg = w.reshape(G, M, D)
    mag = torch.abs(wg)
    order = torch.argsort(mag, 1)
    thr = (lambda x, i, axis: torch.take_along_dim(x, i, dim=axis))(mag, order[:, M - N:M - N + 1, :], 1)
    mask = (lambda x, dt: x.to(dt))(mag >= thr, w.dtype)
    wp = (wg * mask).reshape(D, D)
    return torch.einsum("bsd,df->bsf", x, wp) + b
```

```asm
; @launch grid=(256,1,1) block=(512,1,1) lds=147456
.amdgcn_target "amdgcn-amd-amdhsa--gfx950"
.text
.globl standalone__structured_sparse_n_m__ragged_kernel
.p2align 8
.type standalone__structured_sparse_n_m__ragged_kernel,@function
standalone__structured_sparse_n_m__ragged_kernel:
    s_cmp_ge_u32 s2, 256
    s_cbranch_scc1 L_end
    s_load_dwordx8 s[4:11], s[0:1], 0
    v_lshrrev_b32 v1, 6, v0
    v_and_b32 v2, 63, v0
    s_and_b32 s32, s2, 7
    v_readfirstlane_b32 s38, v1
    s_lshr_b32 s33, s2, 3
    v_lshrrev_b32 v5, 4, v2
    v_and_b32_e64 v6, 15, v2
    s_and_b32 s37, s38, 3
    s_cmp_ge_u32 s33, 26
    s_cbranch_scc1 L_strip
    s_and_b32 s34, s32, 1
    s_mul_i32 s34, s34, 26
    s_add_u32 s34, s34, s33
    s_and_b32 s35, s34, 3
    s_lshr_b32 s34, s34, 2
    s_lshr_b32 s40, s32, 1
    s_mul_i32 s40, s40, 13
    s_add_u32 s34, s34, s40
    s_mul_i32 s39, s34, 184320
    s_lshl_b32 s35, s35, 8
    s_cmp_ge_u32 s38, 4
    s_cbranch_scc0 M_comp
    v_lshlrev_b32 v7, 2, v5
    v_xor_b32_e64 v7, v7, v6
    v_mul_u32_u24 v8, 1152, v5
    v_lshl_add_u32 v8, v7, 4, v8
    v_add_u32 v9, 3584, v8
    v_add_u32 v10, 7168, v8
    v_add_u32 v11, 10752, v8
    v_lshrrev_b32 v3, 3, v2
    v_and_b32 v7, 7, v2
    v_mul_u32_u24 v3, 1152, v3
    v_xor_b32 v4, v7, v5
    s_mul_i32 s24, s37, 5
    s_and_b32 s24, s24, 1
    s_lshl_b32 s24, s24, 2
    v_xor_b32 v4, s24, v4
    v_xor_b32 v7, 4, v4
    v_lshl_add_u32 v12, v4, 4, v3
    v_lshl_add_u32 v13, v7, 4, v3
    v_add_u32 v13, 8192, v13
    v_add_u32 v14, 16384, v12
    v_add_u32 v15, 16384, v13
    s_mul_i32 s24, s37, 46080
    s_add_u32 s24, s24, s39
    s_mov_b32 s26, s24
    s_mov_b32 s14, 9437184
    s_mov_b32 s15, 0x00020000
    s_mul_i32 s22, s37, 18432
    s_add_u32 s22, s22, s35
    s_mov_b32 s40, s22
    s_mul_i32 s27, s37, 4096
    s_mov_b32 m0, s27
    s_mul_i32 s28, s37, 5120
    s_add_u32 s28, s28, 16384
    s_mov_b32 s18, 663552
    s_mov_b32 s19, 0x00020000
    s_waitcnt lgkmcnt(0)
    s_mov_b32 s16, s6
    s_mov_b32 s17, s7
    buffer_load_dwordx4 v8, s[16:19], s40 offen offset:0 lds
    buffer_load_dwordx4 v9, s[16:19], s40 offen offset:1024 lds
    buffer_load_dwordx4 v10, s[16:19], s40 offen offset:2048 lds
    buffer_load_dwordx4 v11, s[16:19], s40 offen offset:3072 lds
    s_add_u32 s40, s40, 73728
    s_mov_b32 s12, s4
    s_mov_b32 s13, s5
    s_add_u32 m0, s28, 0
    s_add_u32 s41, s26, 36864
    buffer_load_dwordx4 v12, s[12:15], s26 offen offset:0  lds
    buffer_load_dwordx4 v13, s[12:15], s26 offen offset:1024  lds
    buffer_load_dwordx4 v14, s[12:15], s26 offen offset:2048  lds
    buffer_load_dwordx4 v15, s[12:15], s26 offen offset:3072  lds
    s_add_u32 m0, s28, 4096
    s_add_u32 s26, s26, 128
    buffer_load_dwordx4 v12, s[12:15], s41 offen offset:0  lds
    s_add_u32 m0, s27, 36864
    s_nop 0
    buffer_load_dwordx4 v8, s[16:19], s40 offen offset:0 lds
    buffer_load_dwordx4 v9, s[16:19], s40 offen offset:1024 lds
    buffer_load_dwordx4 v10, s[16:19], s40 offen offset:2048 lds
    buffer_load_dwordx4 v11, s[16:19], s40 offen offset:3072 lds
    s_add_u32 s40, s40, 73728
    s_add_u32 m0, s28, 36864
    s_add_u32 s41, s26, 36864
    buffer_load_dwordx4 v12, s[12:15], s26 offen offset:0  lds
    buffer_load_dwordx4 v13, s[12:15], s26 offen offset:1024  lds
    buffer_load_dwordx4 v14, s[12:15], s26 offen offset:2048  lds
    buffer_load_dwordx4 v15, s[12:15], s26 offen offset:3072  lds
    s_add_u32 m0, s28, 40960
    s_add_u32 s26, s26, 128
    buffer_load_dwordx4 v12, s[12:15], s41 offen offset:0  lds
    s_waitcnt vmcnt(9)
    s_barrier
    s_add_u32 m0, s27, 73728
    s_nop 0
    buffer_load_dwordx4 v8, s[16:19], s40 offen offset:0 lds
    buffer_load_dwordx4 v9, s[16:19], s40 offen offset:1024 lds
    buffer_load_dwordx4 v10, s[16:19], s40 offen offset:2048 lds
    buffer_load_dwordx4 v11, s[16:19], s40 offen offset:3072 lds
    s_add_u32 s40, s40, 73728
    s_add_u32 m0, s28, 73728
    s_add_u32 s41, s26, 36864
    buffer_load_dwordx4 v12, s[12:15], s26 offen offset:0  lds
    buffer_load_dwordx4 v13, s[12:15], s26 offen offset:1024  lds
    buffer_load_dwordx4 v14, s[12:15], s26 offen offset:2048  lds
    buffer_load_dwordx4 v15, s[12:15], s26 offen offset:3072  lds
    s_add_u32 m0, s28, 77824
    s_add_u32 s26, s26, 128
    buffer_load_dwordx4 v12, s[12:15], s41 offen offset:0  lds
    s_waitcnt vmcnt(9)
    s_barrier
    s_add_u32 m0, s27, 110592
    s_nop 0
    buffer_load_dwordx4 v8, s[16:19], s40 offen offset:0 lds
    buffer_load_dwordx4 v9, s[16:19], s40 offen offset:1024 lds
    buffer_load_dwordx4 v10, s[16:19], s40 offen offset:2048 lds
    buffer_load_dwordx4 v11, s[16:19], s40 offen offset:3072 lds
    s_add_u32 s40, s40, 73728
    s_add_u32 m0, s28, 110592
    s_add_u32 s41, s26, 36864
    buffer_load_dwordx4 v12, s[12:15], s26 offen offset:0  lds
    buffer_load_dwordx4 v13, s[12:15], s26 offen offset:1024  lds
    buffer_load_dwordx4 v14, s[12:15], s26 offen offset:2048  lds
    buffer_load_dwordx4 v15, s[12:15], s26 offen offset:3072  lds
    s_add_u32 m0, s28, 114688
    s_add_u32 s26, s26, 128
    buffer_load_dwordx4 v12, s[12:15], s41 offen offset:0  lds
    s_add_u32 m0, s27, 0
    s_nop 0
    buffer_load_dwordx4 v8, s[16:19], s40 offen offset:0 lds
    buffer_load_dwordx4 v9, s[16:19], s40 offen offset:1024 lds
    buffer_load_dwordx4 v10, s[16:19], s40 offen offset:2048 lds
    buffer_load_dwordx4 v11, s[16:19], s40 offen offset:3072 lds
    s_add_u32 s40, s40, 73728
    s_waitcnt vmcnt(13)
    s_barrier
    s_add_u32 m0, s28, 0
    s_add_u32 s41, s26, 36864
    buffer_load_dwordx4 v12, s[12:15], s26 offen offset:0  lds
    buffer_load_dwordx4 v13, s[12:15], s26 offen offset:1024  lds
    buffer_load_dwordx4 v14, s[12:15], s26 offen offset:2048  lds
    buffer_load_dwordx4 v15, s[12:15], s26 offen offset:3072  lds
    s_add_u32 m0, s28, 4096
    s_add_u32 s26, s26, 128
    buffer_load_dwordx4 v12, s[12:15], s41 offen offset:0  lds
    s_add_u32 m0, s27, 36864
    s_nop 0
    buffer_load_dwordx4 v8, s[16:19], s40 offen offset:0 lds
    buffer_load_dwordx4 v9, s[16:19], s40 offen offset:1024 lds
    buffer_load_dwordx4 v10, s[16:19], s40 offen offset:2048 lds
    buffer_load_dwordx4 v11, s[16:19], s40 offen offset:3072 lds
    s_add_u32 s40, s40, 73728
    s_waitcnt vmcnt(13)
    s_barrier
    s_add_u32 m0, s28, 36864
    s_add_u32 s41, s26, 36864
    buffer_load_dwordx4 v12, s[12:15], s26 offen offset:0  lds
    buffer_load_dwordx4 v13, s[12:15], s26 offen offset:1024  lds
    buffer_load_dwordx4 v14, s[12:15], s26 offen offset:2048  lds
    buffer_load_dwordx4 v15, s[12:15], s26 offen offset:3072  lds
    s_add_u32 m0, s28, 40960
    s_add_u32 s26, s26, 128
    buffer_load_dwordx4 v12, s[12:15], s41 offen offset:0  lds
    s_add_u32 m0, s27, 73728
    s_nop 0
    buffer_load_dwordx4 v8, s[16:19], s40 offen offset:0 lds
    buffer_load_dwordx4 v9, s[16:19], s40 offen offset:1024 lds
    buffer_load_dwordx4 v10, s[16:19], s40 offen offset:2048 lds
    buffer_load_dwordx4 v11, s[16:19], s40 offen offset:3072 lds
    s_add_u32 s40, s40, 73728
    s_waitcnt vmcnt(13)
    s_barrier
    s_add_u32 m0, s28, 73728
    s_add_u32 s41, s26, 36864
    buffer_load_dwordx4 v12, s[12:15], s26 offen offset:0  lds
    buffer_load_dwordx4 v13, s[12:15], s26 offen offset:1024  lds
    buffer_load_dwordx4 v14, s[12:15], s26 offen offset:2048  lds
    buffer_load_dwordx4 v15, s[12:15], s26 offen offset:3072  lds
    s_add_u32 m0, s28, 77824
    s_add_u32 s26, s26, 128
    buffer_load_dwordx4 v12, s[12:15], s41 offen offset:0  lds
    s_add_u32 m0, s27, 110592
    s_nop 0
    buffer_load_dwordx4 v8, s[16:19], s40 offen offset:0 lds
    buffer_load_dwordx4 v9, s[16:19], s40 offen offset:1024 lds
    buffer_load_dwordx4 v10, s[16:19], s40 offen offset:2048 lds
    buffer_load_dwordx4 v11, s[16:19], s40 offen offset:3072 lds
    s_add_u32 s40, s40, 73728
    s_waitcnt vmcnt(13)
    s_barrier
    s_add_u32 m0, s28, 110592
    s_add_u32 s41, s26, 36864
    buffer_load_dwordx4 v12, s[12:15], s26 offen offset:0  lds
    buffer_load_dwordx4 v13, s[12:15], s26 offen offset:1024  lds
    buffer_load_dwordx4 v14, s[12:15], s26 offen offset:2048  lds
    buffer_load_dwordx4 v15, s[12:15], s26 offen offset:3072  lds
    s_add_u32 m0, s28, 114688
    s_add_u32 s26, s26, 128
    buffer_load_dwordx4 v12, s[12:15], s41 offen offset:0  lds
    s_add_u32 m0, s27, 0
    s_nop 0
    buffer_load_dwordx4 v8, s[16:19], s40 offen offset:0 lds
    buffer_load_dwordx4 v9, s[16:19], s40 offen offset:1024 lds
    buffer_load_dwordx4 v10, s[16:19], s40 offen offset:2048 lds
    buffer_load_dwordx4 v11, s[16:19], s40 offen offset:3072 lds
    s_add_u32 s40, s40, 73728
    s_waitcnt vmcnt(13)
    s_barrier
    s_add_u32 m0, s28, 0
    s_add_u32 s41, s26, 36864
    buffer_load_dwordx4 v12, s[12:15], s26 offen offset:0  lds
    buffer_load_dwordx4 v13, s[12:15], s26 offen offset:1024  lds
    buffer_load_dwordx4 v14, s[12:15], s26 offen offset:2048  lds
    buffer_load_dwordx4 v15, s[12:15], s26 offen offset:3072  lds
    s_add_u32 m0, s28, 4096
    s_add_u32 s26, s26, 128
    buffer_load_dwordx4 v12, s[12:15], s41 offen offset:0  lds
    s_waitcnt vmcnt(9)
    s_barrier
    s_waitcnt vmcnt(0)
    s_barrier
    s_branch M_outA
M_comp:
    s_mov_b32 s40, s37
    s_mov_b32 s41, 0
    v_and_b32 v3, 31, v2
    v_lshrrev_b32 v4, 5, v2
    s_lshl_b32 s42, s40, 6
    s_add_u32 s42, s42, s35
    v_lshlrev_b32 v7, 3, v4
    v_add_u32 v7, s42, v7
    s_mov_b32 s20, 0x7fff7fff
    s_mov_b32 s21, 0x000f000f
    s_waitcnt lgkmcnt(0)
    s_mov_b32 s12, s8
    s_mov_b32 s13, s9
    s_mov_b32 s14, 1152
    s_mov_b32 s15, 0x00020000
    buffer_load_dwordx2 v[132:133], v7, s[12:15], 0 offen offset:0
    buffer_load_dwordx2 v[134:135], v7, s[12:15], 0 offen offset:16
    buffer_load_dwordx2 v[136:137], v7, s[12:15], 0 offen offset:32
    buffer_load_dwordx2 v[138:139], v7, s[12:15], 0 offen offset:48
    v_add_u32 v7, s41, v3
    v_bfe_u32 v8, v7, 1, 3
    v_xor_b32 v8, v8, v4
    v_lshlrev_b32 v7, 7, v7
    v_add_u32 v7, 16384, v7
    v_lshl_add_u32 v10, v8, 4, v7
    v_xor_b32_e64 v9, 2, v8
    v_lshl_add_u32 v11, v9, 4, v7
    v_xor_b32_e64 v9, 4, v8
    v_lshl_add_u32 v12, v9, 4, v7
    v_xor_b32_e64 v9, 6, v8
    v_lshl_add_u32 v13, v9, 4, v7
    v_lshrrev_b32_e64 v7, 2, v6
    v_lshl_add_u32 v8, v4, 3, v7
    v_mul_u32_u24 v8, 256, v8
    v_and_b32_e64 v9, 1, v5
    v_lshl_add_u32 v8, v9, 5, v8
    v_and_b32_e64 v9, 3, v6
    v_lshl_add_u32 v8, v9, 3, v8
    v_xor_b32_e64 v9, s40, v7
    v_lshl_add_u32 v14, v9, 6, v8
    v_add_u32 v7, s41, v3
    v_and_b32 v15, 7, v7
    v_xor_b32 v15, v15, v4
    s_lshl_b32 s42, s40, 2
    v_xor_b32_e64 v15, s42, v15
    v_mul_u32_u24 v7, 256, v7
    v_add_u32 v7, 36864, v7
    v_lshl_add_u32 v8, v15, 4, v7
    v_xor_b32_e64 v15, 2, v15
    v_lshl_add_u32 v9, v15, 4, v7
    v_lshrrev_b32 v7, 4, v2
    s_mul_i32 s44, s38, 4
    s_lshr_b32 s45, s38, 2
    s_mul_i32 s45, s45, 0
    s_add_u32 s44, s44, s45
    v_add_u32 v7, s44, v7
    v_and_b32 v1, 15, v2
    v_and_b32 v15, 7, v7
    v_xor_b32_e64 v15, v15, v1
    v_mul_u32_u24 v5, 256, v7
    v_lshl_add_u32 v5, v15, 4, v5
    v_add_u32 v5, 36864, v5
    v_mul_u32_u24 v6, 1152, v7
    v_lshl_add_u32 v6, v1, 4, v6
    s_add_u32 s44, s39, s35
    s_mov_b32 s16, s10
    s_mov_b32 s17, s11
    s_mov_b32 s18, 9437184
    s_mov_b32 s19, 0x00020000
    v_add_u32 v7, s41, v3
    v_and_b32 v15, 7, v7
    s_lshl_b32 s42, s40, 2
    v_xor_b32_e64 v15, s42, v15
    v_mul_u32_u24 v7, 256, v7
    v_lshl_add_u32 v7, v4, 3, v7
    v_add_u32 v7, 36864, v7
    v_lshl_add_u32 v8, v15, 4, v7
    v_xor_b32 v9, 16, v8
    v_xor_b32 v1, 32, v8
    v_xor_b32 v15, 48, v8
    s_mov_b32 s50, 0
    s_mov_b32 s53, 36864
    s_mov_b32 s51, 4294893568
    s_waitcnt vmcnt(0)
    v_lshlrev_b32 v16, 16, v132
    v_and_b32 v17, 0xffff0000, v132
    v_lshlrev_b32_e64 v18, 16, v133
    v_and_b32 v19, 0xffff0000, v133
    v_lshlrev_b32_e64 v20, 16, v134
    v_and_b32 v21, 0xffff0000, v134
    v_lshlrev_b32_e64 v22, 16, v135
    v_and_b32 v23, 0xffff0000, v135
    v_lshlrev_b32_e64 v24, 16, v136
    v_and_b32 v25, 0xffff0000, v136
    v_lshlrev_b32_e64 v26, 16, v137
    v_and_b32 v27, 0xffff0000, v137
    v_lshlrev_b32_e64 v28, 16, v138
    v_and_b32 v29, 0xffff0000, v138
    v_lshlrev_b32_e64 v30, 16, v139
    v_and_b32 v31, 0xffff0000, v139
    v_mov_b64 v[32:33], v[16:17]
    v_mov_b64 v[34:35], v[18:19]
    v_mov_b64 v[36:37], v[20:21]
    v_mov_b64 v[38:39], v[22:23]
    v_mov_b64 v[40:41], v[24:25]
    v_mov_b64 v[42:43], v[26:27]
    v_mov_b64 v[44:45], v[28:29]
    v_mov_b64 v[46:47], v[30:31]
    v_mov_b64 v[48:49], v[16:17]
    v_mov_b64 v[50:51], v[18:19]
    v_mov_b64 v[52:53], v[20:21]
    v_mov_b64 v[54:55], v[22:23]
    v_mov_b64 v[56:57], v[24:25]
    v_mov_b64 v[58:59], v[26:27]
    v_mov_b64 v[60:61], v[28:29]
    v_mov_b64 v[62:63], v[30:31]
    v_mov_b64 v[64:65], v[16:17]
    v_mov_b64 v[66:67], v[18:19]
    v_mov_b64 v[68:69], v[20:21]
    v_mov_b64 v[70:71], v[22:23]
    v_mov_b64 v[72:73], v[24:25]
    v_mov_b64 v[74:75], v[26:27]
    v_mov_b64 v[76:77], v[28:29]
    v_mov_b64 v[78:79], v[30:31]
    v_mov_b64 v[80:81], v[16:17]
    v_mov_b64 v[82:83], v[18:19]
    v_mov_b64 v[84:85], v[20:21]
    v_mov_b64 v[86:87], v[22:23]
    v_mov_b64 v[88:89], v[24:25]
    v_mov_b64 v[90:91], v[26:27]
    v_mov_b64 v[92:93], v[28:29]
    v_mov_b64 v[94:95], v[30:31]
    s_setprio 1
    s_barrier
    ds_read_b64_tr_b16 v[96:97], v14 offset:0
    ds_read_b64_tr_b16 v[98:99], v14 offset:1024
    ds_read_b128 v[132:135], v10 offset:0
    ds_read_b128 v[136:139], v10 offset:4096
    ds_read_b128 v[140:143], v10 offset:8192
    ds_read_b128 v[144:147], v10 offset:12288
    ds_read_b128 v[148:151], v10 offset:16384
    ds_read_b64_tr_b16 v[100:101], v14 offset:4096
    ds_read_b64_tr_b16 v[102:103], v14 offset:5120
    ds_read_b128 v[152:155], v11 offset:0
    ds_read_b128 v[156:159], v11 offset:4096
    ds_read_b128 v[160:163], v11 offset:8192
    ds_read_b128 v[164:167], v11 offset:12288
    ds_read_b128 v[168:171], v11 offset:16384
    ds_read_b64_tr_b16 v[104:105], v14 offset:8192
    ds_read_b64_tr_b16 v[106:107], v14 offset:9216
    ds_read_b128 v[172:175], v12 offset:0
    ds_read_b128 v[176:179], v12 offset:4096
    ds_read_b128 v[180:183], v12 offset:8192
    ds_read_b128 v[184:187], v12 offset:12288
    ds_read_b128 v[188:191], v12 offset:16384
    s_waitcnt lgkmcnt(15)
    v_and_b32 v112, s20, v96
    v_and_b32 v113, s20, v97
    v_and_b32 v117, s20, v98
    v_and_b32_e64 v118, s20, v99
    v_pk_max_u16 v114, v112, v113
    v_pk_min_u16 v115, v112, v113
    v_pk_max_u16 v119, v117, v118
    v_pk_min_u16 v120, v117, v118
    v_pk_min_u16 v114, v114, v114 op_sel:[0,1] op_sel_hi:[1,0]
    v_pk_max_u16 v115, v115, v115 op_sel:[0,1] op_sel_hi:[1,0]
    v_pk_min_u16 v119, v119, v119 op_sel:[0,1] op_sel_hi:[1,0]
    v_pk_max_u16 v120, v120, v120 op_sel:[0,1] op_sel_hi:[1,0]
    v_pk_max_u16 v114, v114, v115
    v_pk_max_u16 v119, v119, v120
    v_pk_sub_i16 v112, v112, v114
    v_pk_sub_i16 v113, v113, v114
    v_pk_sub_i16 v117, v117, v119
    v_pk_sub_i16 v118, v118, v119
    v_pk_ashrrev_i16 v112, s21, v112
    v_pk_ashrrev_i16 v113, s21, v113
    v_pk_ashrrev_i16 v117, s21, v117
    v_pk_ashrrev_i16 v118, s21, v118
    v_bfi_b32 v96, v112, 0, v96
    v_bfi_b32 v97, v113, 0, v97
    v_bfi_b32 v98, v117, 0, v98
    v_bfi_b32 v99, v118, 0, v99
    s_waitcnt lgkmcnt(12)
    v_and_b32 v122, s20, v100
    v_and_b32 v123, s20, v101
    v_and_b32 v127, s20, v102
    v_and_b32_e64 v128, s20, v103
    v_pk_max_u16 v124, v122, v123
    v_pk_min_u16 v125, v122, v123
    v_pk_max_u16 v129, v127, v128
    v_pk_min_u16 v130, v127, v128
    v_pk_min_u16 v124, v124, v124 op_sel:[0,1] op_sel_hi:[1,0]
    v_pk_max_u16 v125, v125, v125 op_sel:[0,1] op_sel_hi:[1,0]
    v_pk_min_u16 v129, v129, v129 op_sel:[0,1] op_sel_hi:[1,0]
    v_pk_max_u16 v130, v130, v130 op_sel:[0,1] op_sel_hi:[1,0]
    v_pk_max_u16 v124, v124, v125
    v_pk_max_u16 v129, v129, v130
M_loop:
    s_waitcnt lgkmcnt(5)
    v_and_b32 v112, s20, v104
    v_mfma_f32_32x32x16_bf16 v[16:31], v[96:99], v[132:135], v[16:31]
    ds_read_b64_tr_b16 v[108:109], v14 offset:12288
    ds_read_b64_tr_b16 v[110:111], v14 offset:13312
    v_pk_sub_i16 v122, v122, v124
    v_and_b32_e64 v113, s20, v105
    v_pk_sub_i16 v123, v123, v124
    v_and_b32_e64 v117, s20, v106
    v_mfma_f32_32x32x16_bf16 v[32:47], v[96:99], v[136:139], v[32:47]
    ds_read_b128 v[192:195], v13 offset:0
    ds_read_b128 v[196:199], v13 offset:4096
    v_pk_sub_i16 v127, v127, v129
    v_and_b32_e64 v118, s20, v107
    v_pk_sub_i16 v128, v128, v129
    v_pk_ashrrev_i16 v122, s21, v122
    v_mfma_f32_32x32x16_bf16 v[48:63], v[96:99], v[140:143], v[48:63]
    ds_read_b128 v[200:203], v13 offset:8192
    ds_read_b128 v[204:207], v13 offset:12288
    v_pk_max_u16 v114, v112, v113
    v_pk_ashrrev_i16 v123, s21, v123
    v_pk_min_u16 v115, v112, v113
    v_pk_ashrrev_i16 v127, s21, v127
    v_pk_max_u16 v119, v117, v118
    v_mfma_f32_32x32x16_bf16 v[64:79], v[96:99], v[144:147], v[64:79]
    ds_read_b128 v[208:211], v13 offset:16384
    v_pk_ashrrev_i16 v128, s21, v128
    v_bfi_b32 v100, v122, 0, v100
    v_pk_min_u16 v120, v117, v118
    v_bfi_b32 v101, v123, 0, v101
    v_pk_min_u16 v114, v114, v114 op_sel:[0,1] op_sel_hi:[1,0]
    v_mfma_f32_32x32x16_bf16 v[80:95], v[96:99], v[148:151], v[80:95]
    v_bfi_b32 v102, v127, 0, v102
    v_pk_max_u16 v115, v115, v115 op_sel:[0,1] op_sel_hi:[1,0]
    v_bfi_b32 v103, v128, 0, v103
    v_pk_min_u16 v119, v119, v119 op_sel:[0,1] op_sel_hi:[1,0]
    v_pk_max_u16 v120, v120, v120 op_sel:[0,1] op_sel_hi:[1,0]
    v_pk_max_u16 v114, v114, v115
    v_pk_max_u16 v119, v119, v120
    s_waitcnt lgkmcnt(5)
    v_and_b32 v122, s20, v108
    v_mfma_f32_32x32x16_bf16 v[16:31], v[100:103], v[152:155], v[16:31]
    v_pk_sub_i16 v112, v112, v114
    v_and_b32_e64 v123, s20, v109
    v_pk_sub_i16 v113, v113, v114
    v_and_b32_e64 v127, s20, v110
    v_pk_sub_i16 v117, v117, v119
    v_and_b32_e64 v128, s20, v111
    s_waitcnt lgkmcnt(0)
    s_barrier
M_nobar0:
    v_mfma_f32_32x32x16_bf16 v[32:47], v[100:103], v[156:159], v[32:47]
    ds_read_b64_tr_b16 v[96:97], v14 offset:36864
    ds_read_b64_tr_b16 v[98:99], v14 offset:37888
    v_pk_sub_i16 v118, v118, v119
    v_pk_ashrrev_i16 v112, s21, v112
    v_pk_max_u16 v124, v122, v123
    v_pk_ashrrev_i16 v113, s21, v113
    v_mfma_f32_32x32x16_bf16 v[48:63], v[100:103], v[160:163], v[48:63]
    ds_read_b128 v[132:135], v10 offset:36864
    ds_read_b128 v[136:139], v10 offset:40960
    v_pk_min_u16 v125, v122, v123
    v_pk_ashrrev_i16 v117, s21, v117
    v_pk_max_u16 v129, v127, v128
    v_pk_ashrrev_i16 v118, s21, v118
    v_bfi_b32 v104, v112, 0, v104
    v_mfma_f32_32x32x16_bf16 v[64:79], v[100:103], v[164:167], v[64:79]
    ds_read_b128 v[140:143], v10 offset:45056
    ds_read_b128 v[144:147], v10 offset:49152
    v_pk_min_u16 v130, v127, v128
    v_bfi_b32 v105, v113, 0, v105
    v_pk_min_u16 v124, v124, v124 op_sel:[0,1] op_sel_hi:[1,0]
    v_bfi_b32 v106, v117, 0, v106
    v_mfma_f32_32x32x16_bf16 v[80:95], v[100:103], v[168:171], v[80:95]
    ds_read_b128 v[148:151], v10 offset:53248
    v_pk_max_u16 v125, v125, v125 op_sel:[0,1] op_sel_hi:[1,0]
    v_bfi_b32 v107, v118, 0, v107
    v_pk_min_u16 v129, v129, v129 op_sel:[0,1] op_sel_hi:[1,0]
    v_pk_max_u16 v130, v130, v130 op_sel:[0,1] op_sel_hi:[1,0]
    v_pk_max_u16 v124, v124, v125
    v_pk_max_u16 v129, v129, v130
    s_waitcnt lgkmcnt(5)
    v_and_b32 v112, s20, v96
    v_mfma_f32_32x32x16_bf16 v[16:31], v[104:107], v[172:175], v[16:31]
    ds_read_b64_tr_b16 v[100:101], v14 offset:40960
    ds_read_b64_tr_b16 v[102:103], v14 offset:41984
    v_pk_sub_i16 v122, v122, v124
    v_and_b32_e64 v113, s20, v97
    v_pk_sub_i16 v123, v123, v124
    v_and_b32_e64 v117, s20, v98
    v_mfma_f32_32x32x16_bf16 v[32:47], v[104:107], v[176:179], v[32:47]
    ds_read_b128 v[152:155], v11 offset:36864
    v_pk_sub_i16 v127, v127, v129
    v_and_b32_e64 v118, s20, v99
    v_pk_sub_i16 v128, v128, v129
    v_pk_ashrrev_i16 v122, s21, v122
    v_pk_max_u16 v114, v112, v113
    v_mfma_f32_32x32x16_bf16 v[48:63], v[104:107], v[180:183], v[48:63]
    ds_read_b128 v[156:159], v11 offset:40960
    ds_read_b128 v[160:163], v11 offset:45056
    v_pk_ashrrev_i16 v123, s21, v123
    v_pk_min_u16 v115, v112, v113
    v_pk_ashrrev_i16 v127, s21, v127
    v_pk_max_u16 v119, v117, v118
    v_pk_ashrrev_i16 v128, s21, v128
    v_mfma_f32_32x32x16_bf16 v[64:79], v[104:107], v[184:187], v[64:79]
    ds_read_b128 v[164:167], v11 offset:49152
    v_bfi_b32 v108, v122, 0, v108
    v_pk_min_u16 v120, v117, v118
    v_bfi_b32 v109, v123, 0, v109
    v_pk_min_u16 v114, v114, v114 op_sel:[0,1] op_sel_hi:[1,0]
    v_bfi_b32 v110, v127, 0, v110
    v_mfma_f32_32x32x16_bf16 v[80:95], v[104:107], v[188:191], v[80:95]
    ds_read_b128 v[168:171], v11 offset:53248
    v_pk_max_u16 v115, v115, v115 op_sel:[0,1] op_sel_hi:[1,0]
    v_bfi_b32 v111, v128, 0, v111
    v_pk_min_u16 v119, v119, v119 op_sel:[0,1] op_sel_hi:[1,0]
    v_pk_max_u16 v120, v120, v120 op_sel:[0,1] op_sel_hi:[1,0]
    v_pk_max_u16 v114, v114, v115
    v_pk_max_u16 v119, v119, v120
    s_waitcnt lgkmcnt(5)
    v_and_b32 v122, s20, v100
    v_mfma_f32_32x32x16_bf16 v[16:31], v[108:111], v[192:195], v[16:31]
    ds_read_b64_tr_b16 v[104:105], v14 offset:45056
    ds_read_b64_tr_b16 v[106:107], v14 offset:46080
    v_pk_sub_i16 v112, v112, v114
    v_and_b32_e64 v123, s20, v101
    v_pk_sub_i16 v113, v113, v114
    v_and_b32_e64 v127, s20, v102
    v_mfma_f32_32x32x16_bf16 v[32:47], v[108:111], v[196:199], v[32:47]
    ds_read_b128 v[172:175], v12 offset:36864
    v_pk_sub_i16 v117, v117, v119
    v_and_b32_e64 v128, s20, v103
    v_pk_sub_i16 v118, v118, v119
    v_pk_ashrrev_i16 v112, s21, v112
    v_pk_max_u16 v124, v122, v123
    v_mfma_f32_32x32x16_bf16 v[48:63], v[108:111], v[200:203], v[48:63]
    ds_read_b128 v[176:179], v12 offset:40960
    ds_read_b128 v[180:183], v12 offset:45056
    v_pk_ashrrev_i16 v113, s21, v113
    v_pk_min_u16 v125, v122, v123
    v_pk_ashrrev_i16 v117, s21, v117
    v_pk_max_u16 v129, v127, v128
    v_pk_ashrrev_i16 v118, s21, v118
    v_mfma_f32_32x32x16_bf16 v[64:79], v[108:111], v[204:207], v[64:79]
    ds_read_b128 v[184:187], v12 offset:49152
    v_bfi_b32 v96, v112, 0, v96
    v_pk_min_u16 v130, v127, v128
    v_bfi_b32 v97, v113, 0, v97
    v_pk_min_u16 v124, v124, v124 op_sel:[0,1] op_sel_hi:[1,0]
    v_bfi_b32 v98, v117, 0, v98
    v_mfma_f32_32x32x16_bf16 v[80:95], v[108:111], v[208:211], v[80:95]
    ds_read_b128 v[188:191], v12 offset:53248
    v_pk_max_u16 v125, v125, v125 op_sel:[0,1] op_sel_hi:[1,0]
    v_bfi_b32 v99, v118, 0, v99
    v_pk_min_u16 v129, v129, v129 op_sel:[0,1] op_sel_hi:[1,0]
    v_pk_max_u16 v130, v130, v130 op_sel:[0,1] op_sel_hi:[1,0]
    v_pk_max_u16 v124, v124, v125
    v_pk_max_u16 v129, v129, v130
    s_waitcnt lgkmcnt(5)
    v_and_b32 v112, s20, v104
    v_mfma_f32_32x32x16_bf16 v[16:31], v[96:99], v[132:135], v[16:31]
    ds_read_b64_tr_b16 v[108:109], v14 offset:49152
    ds_read_b64_tr_b16 v[110:111], v14 offset:50176
    v_pk_sub_i16 v122, v122, v124
    v_and_b32_e64 v113, s20, v105
    v_pk_sub_i16 v123, v123, v124
    v_and_b32_e64 v117, s20, v106
    v_mfma_f32_32x32x16_bf16 v[32:47], v[96:99], v[136:139], v[32:47]
    ds_read_b128 v[192:195], v13 offset:36864
    ds_read_b128 v[196:199], v13 offset:40960
    v_pk_sub_i16 v127, v127, v129
    v_and_b32_e64 v118, s20, v107
    v_pk_sub_i16 v128, v128, v129
    v_pk_ashrrev_i16 v122, s21, v122
    v_mfma_f32_32x32x16_bf16 v[48:63], v[96:99], v[140:143], v[48:63]
    ds_read_b128 v[200:203], v13 offset:45056
    ds_read_b128 v[204:207], v13 offset:49152
    v_pk_max_u16 v114, v112, v113
    v_pk_ashrrev_i16 v123, s21, v123
    v_pk_min_u16 v115, v112, v113
    v_pk_ashrrev_i16 v127, s21, v127
    v_pk_max_u16 v119, v117, v118
    v_mfma_f32_32x32x16_bf16 v[64:79], v[96:99], v[144:147], v[64:79]
    ds_read_b128 v[208:211], v13 offset:53248
    v_pk_ashrrev_i16 v128, s21, v128
    v_bfi_b32 v100, v122, 0, v100
    v_pk_min_u16 v120, v117, v118
    v_bfi_b32 v101, v123, 0, v101
    v_pk_min_u16 v114, v114, v114 op_sel:[0,1] op_sel_hi:[1,0]
    v_mfma_f32_32x32x16_bf16 v[80:95], v[96:99], v[148:151], v[80:95]
    v_bfi_b32 v102, v127, 0, v102
    v_pk_max_u16 v115, v115, v115 op_sel:[0,1] op_sel_hi:[1,0]
    v_bfi_b32 v103, v128, 0, v103
    v_pk_min_u16 v119, v119, v119 op_sel:[0,1] op_sel_hi:[1,0]
    v_pk_max_u16 v120, v120, v120 op_sel:[0,1] op_sel_hi:[1,0]
    v_pk_max_u16 v114, v114, v115
    v_pk_max_u16 v119, v119, v120
    s_add_u32 s50, s50, 1
    s_sub_u32 s51, 0, s51
    v_add_u32 v14, s51, v14
    v_add_u32 v10, s51, v10
    s_waitcnt lgkmcnt(5)
    v_and_b32 v122, s20, v108
    v_mfma_f32_32x32x16_bf16 v[16:31], v[100:103], v[152:155], v[16:31]
    v_pk_sub_i16 v112, v112, v114
    v_and_b32_e64 v123, s20, v109
    v_pk_sub_i16 v113, v113, v114
    v_and_b32_e64 v127, s20, v110
    v_pk_sub_i16 v117, v117, v119
    v_and_b32 v128, s20, v111
    v_add_u32 v13, s51, v13
    s_waitcnt lgkmcnt(0)
    s_barrier
M_nobar1:
    v_mfma_f32_32x32x16_bf16 v[32:47], v[100:103], v[156:159], v[32:47]
    ds_read_b64_tr_b16 v[96:97], v14 offset:0
    ds_read_b64_tr_b16 v[98:99], v14 offset:1024
    v_pk_sub_i16 v118, v118, v119
    v_pk_ashrrev_i16 v112, s21, v112
    v_pk_max_u16 v124, v122, v123
    v_pk_ashrrev_i16 v113, s21, v113
    v_mfma_f32_32x32x16_bf16 v[48:63], v[100:103], v[160:163], v[48:63]
    ds_read_b128 v[132:135], v10 offset:0
    ds_read_b128 v[136:139], v10 offset:4096
    v_pk_min_u16 v125, v122, v123
    v_pk_ashrrev_i16 v117, s21, v117
    v_pk_max_u16 v129, v127, v128
    v_pk_ashrrev_i16 v118, s21, v118
    v_bfi_b32 v104, v112, 0, v104
    v_mfma_f32_32x32x16_bf16 v[64:79], v[100:103], v[164:167], v[64:79]
    ds_read_b128 v[140:143], v10 offset:8192
    ds_read_b128 v[144:147], v10 offset:12288
    v_pk_min_u16 v130, v127, v128
    v_bfi_b32 v105, v113, 0, v105
    v_pk_min_u16 v124, v124, v124 op_sel:[0,1] op_sel_hi:[1,0]
    v_bfi_b32 v106, v117, 0, v106
    v_mfma_f32_32x32x16_bf16 v[80:95], v[100:103], v[168:171], v[80:95]
    ds_read_b128 v[148:151], v10 offset:16384
    v_pk_max_u16 v125, v125, v125 op_sel:[0,1] op_sel_hi:[1,0]
    v_bfi_b32 v107, v118, 0, v107
    v_pk_min_u16 v129, v129, v129 op_sel:[0,1] op_sel_hi:[1,0]
    v_pk_max_u16 v130, v130, v130 op_sel:[0,1] op_sel_hi:[1,0]
    v_pk_max_u16 v124, v124, v125
    v_pk_max_u16 v129, v129, v130
    v_add_u32 v11, s51, v11
    s_waitcnt lgkmcnt(5)
    v_and_b32_e64 v112, s20, v96
    v_mfma_f32_32x32x16_bf16 v[16:31], v[104:107], v[172:175], v[16:31]
    ds_read_b64_tr_b16 v[100:101], v14 offset:4096
    ds_read_b64_tr_b16 v[102:103], v14 offset:5120
    v_pk_sub_i16 v122, v122, v124
    v_and_b32_e64 v113, s20, v97
    v_pk_sub_i16 v123, v123, v124
    v_and_b32_e64 v117, s20, v98
    v_mfma_f32_32x32x16_bf16 v[32:47], v[104:107], v[176:179], v[32:47]
    ds_read_b128 v[152:155], v11 offset:0
    v_pk_sub_i16 v127, v127, v129
    v_and_b32_e64 v118, s20, v99
    v_pk_sub_i16 v128, v128, v129
    v_pk_ashrrev_i16 v122, s21, v122
    v_pk_max_u16 v114, v112, v113
    v_mfma_f32_32x32x16_bf16 v[48:63], v[104:107], v[180:183], v[48:63]
    ds_read_b128 v[156:159], v11 offset:4096
    ds_read_b128 v[160:163], v11 offset:8192
    v_pk_ashrrev_i16 v123, s21, v123
    v_pk_min_u16 v115, v112, v113
    v_pk_ashrrev_i16 v127, s21, v127
    v_pk_max_u16 v119, v117, v118
    v_pk_ashrrev_i16 v128, s21, v128
    v_mfma_f32_32x32x16_bf16 v[64:79], v[104:107], v[184:187], v[64:79]
    ds_read_b128 v[164:167], v11 offset:12288
    v_bfi_b32 v108, v122, 0, v108
    v_pk_min_u16 v120, v117, v118
    v_bfi_b32 v109, v123, 0, v109
    v_pk_min_u16 v114, v114, v114 op_sel:[0,1] op_sel_hi:[1,0]
    v_bfi_b32 v110, v127, 0, v110
    v_mfma_f32_32x32x16_bf16 v[80:95], v[104:107], v[188:191], v[80:95]
    ds_read_b128 v[168:171], v11 offset:16384
    v_pk_max_u16 v115, v115, v115 op_sel:[0,1] op_sel_hi:[1,0]
    v_bfi_b32 v111, v128, 0, v111
    v_pk_min_u16 v119, v119, v119 op_sel:[0,1] op_sel_hi:[1,0]
    v_pk_max_u16 v120, v120, v120 op_sel:[0,1] op_sel_hi:[1,0]
    v_pk_max_u16 v114, v114, v115
    v_pk_max_u16 v119, v119, v120
    v_add_u32 v12, s51, v12
    s_waitcnt lgkmcnt(5)
    v_and_b32_e64 v122, s20, v100
    v_mfma_f32_32x32x16_bf16 v[16:31], v[108:111], v[192:195], v[16:31]
    ds_read_b64_tr_b16 v[104:105], v14 offset:8192
    ds_read_b64_tr_b16 v[106:107], v14 offset:9216
    v_pk_sub_i16 v112, v112, v114
    v_and_b32_e64 v123, s20, v101
    v_pk_sub_i16 v113, v113, v114
    v_and_b32_e64 v127, s20, v102
    v_mfma_f32_32x32x16_bf16 v[32:47], v[108:111], v[196:199], v[32:47]
    ds_read_b128 v[172:175], v12 offset:0
    v_pk_sub_i16 v117, v117, v119
    v_and_b32_e64 v128, s20, v103
    v_pk_sub_i16 v118, v118, v119
    v_pk_ashrrev_i16 v112, s21, v112
    v_pk_max_u16 v124, v122, v123
    v_mfma_f32_32x32x16_bf16 v[48:63], v[108:111], v[200:203], v[48:63]
    ds_read_b128 v[176:179], v12 offset:4096
    ds_read_b128 v[180:183], v12 offset:8192
    v_pk_ashrrev_i16 v113, s21, v113
    v_pk_min_u16 v125, v122, v123
    v_pk_ashrrev_i16 v117, s21, v117
    v_pk_max_u16 v129, v127, v128
    v_pk_ashrrev_i16 v118, s21, v118
    v_mfma_f32_32x32x16_bf16 v[64:79], v[108:111], v[204:207], v[64:79]
    ds_read_b128 v[184:187], v12 offset:12288
    v_bfi_b32 v96, v112, 0, v96
    v_pk_min_u16 v130, v127, v128
    v_bfi_b32 v97, v113, 0, v97
    v_pk_min_u16 v124, v124, v124 op_sel:[0,1] op_sel_hi:[1,0]
    v_bfi_b32 v98, v117, 0, v98
    v_mfma_f32_32x32x16_bf16 v[80:95], v[108:111], v[208:211], v[80:95]
    ds_read_b128 v[188:191], v12 offset:16384
    v_pk_max_u16 v125, v125, v125 op_sel:[0,1] op_sel_hi:[1,0]
    v_bfi_b32 v99, v118, 0, v99
    v_pk_min_u16 v129, v129, v129 op_sel:[0,1] op_sel_hi:[1,0]
    v_pk_max_u16 v130, v130, v130 op_sel:[0,1] op_sel_hi:[1,0]
    v_pk_max_u16 v124, v124, v125
    v_pk_max_u16 v129, v129, v130
    s_cmp_lt_u32 s50, 4
    s_cbranch_scc1 M_loop
    v_mfma_f32_32x32x16_bf16 v[16:31], v[96:99], v[132:135], v[16:31]
    ds_read_b64_tr_b16 v[108:109], v14 offset:12288
    ds_read_b64_tr_b16 v[110:111], v14 offset:13312
    v_pk_sub_i16 v122, v122, v124
    ds_read_b128 v[192:195], v13 offset:0
    s_waitcnt lgkmcnt(8)
    v_and_b32 v112, s20, v104
    ds_read_b128 v[196:199], v13 offset:4096
    v_mfma_f32_32x32x16_bf16 v[32:47], v[96:99], v[136:139], v[32:47]
    v_pk_sub_i16 v123, v123, v124
    ds_read_b128 v[200:203], v13 offset:8192
    v_and_b32_e64 v113, s20, v105
    ds_read_b128 v[204:207], v13 offset:12288
    v_pk_sub_i16 v127, v127, v129
    ds_read_b128 v[208:211], v13 offset:16384
    v_and_b32_e64 v117, s20, v106
    v_mfma_f32_32x32x16_bf16 v[48:63], v[96:99], v[140:143], v[48:63]
    v_pk_sub_i16 v128, v128, v129
    v_and_b32_e64 v118, s20, v107
    v_pk_ashrrev_i16 v122, s21, v122
    v_pk_max_u16 v114, v112, v113
    v_pk_ashrrev_i16 v123, s21, v123
    v_pk_min_u16 v115, v112, v113
    v_mfma_f32_32x32x16_bf16 v[64:79], v[96:99], v[144:147], v[64:79]
    v_pk_ashrrev_i16 v127, s21, v127
    v_pk_max_u16 v119, v117, v118
    v_pk_ashrrev_i16 v128, s21, v128
    v_pk_min_u16 v120, v117, v118
    v_bfi_b32 v100, v122, 0, v100
    v_pk_min_u16 v114, v114, v114 op_sel:[0,1] op_sel_hi:[1,0]
    v_bfi_b32 v101, v123, 0, v101
    v_mfma_f32_32x32x16_bf16 v[80:95], v[96:99], v[148:151], v[80:95]
    v_pk_max_u16 v115, v115, v115 op_sel:[0,1] op_sel_hi:[1,0]
    v_bfi_b32 v102, v127, 0, v102
    v_pk_min_u16 v119, v119, v119 op_sel:[0,1] op_sel_hi:[1,0]
    v_bfi_b32 v103, v128, 0, v103
    v_pk_max_u16 v120, v120, v120 op_sel:[0,1] op_sel_hi:[1,0]
    v_pk_max_u16 v114, v114, v115
    v_pk_max_u16 v119, v119, v120
    v_mfma_f32_32x32x16_bf16 v[16:31], v[100:103], v[152:155], v[16:31]
    v_pk_sub_i16 v112, v112, v114
    s_waitcnt lgkmcnt(5)
    v_and_b32 v122, s20, v108
    v_pk_sub_i16 v113, v113, v114
    v_and_b32_e64 v123, s20, v109
    v_pk_sub_i16 v117, v117, v119
    v_and_b32_e64 v127, s20, v110
    v_pk_sub_i16 v118, v118, v119
    v_and_b32_e64 v128, s20, v111
    v_pk_ashrrev_i16 v112, s21, v112
    v_pk_max_u16 v124, v122, v123
    v_pk_ashrrev_i16 v113, s21, v113
    v_pk_min_u16 v125, v122, v123
    v_pk_ashrrev_i16 v117, s21, v117
    v_mfma_f32_32x32x16_bf16 v[32:47], v[100:103], v[156:159], v[32:47]
    v_pk_max_u16 v129, v127, v128
    v_pk_ashrrev_i16 v118, s21, v118
    v_pk_min_u16 v130, v127, v128
    v_bfi_b32 v104, v112, 0, v104
    v_pk_min_u16 v124, v124, v124 op_sel:[0,1] op_sel_hi:[1,0]
    v_bfi_b32 v105, v113, 0, v105
    v_pk_max_u16 v125, v125, v125 op_sel:[0,1] op_sel_hi:[1,0]
    v_bfi_b32 v106, v117, 0, v106
    v_pk_min_u16 v129, v129, v129 op_sel:[0,1] op_sel_hi:[1,0]
    v_bfi_b32 v107, v118, 0, v107
    v_pk_max_u16 v130, v130, v130 op_sel:[0,1] op_sel_hi:[1,0]
    v_pk_max_u16 v124, v124, v125
    v_pk_max_u16 v129, v129, v130
    v_mfma_f32_32x32x16_bf16 v[16:31], v[104:107], v[172:175], v[16:31]
    v_pk_sub_i16 v122, v122, v124
    v_pk_sub_i16 v123, v123, v124
    v_pk_sub_i16 v127, v127, v129
    v_pk_sub_i16 v128, v128, v129
    v_pk_ashrrev_i16 v122, s21, v122
    v_pk_ashrrev_i16 v123, s21, v123
    v_mfma_f32_32x32x16_bf16 v[32:47], v[104:107], v[176:179], v[32:47]
    v_pk_ashrrev_i16 v127, s21, v127
    v_pk_ashrrev_i16 v128, s21, v128
    v_bfi_b32 v108, v122, 0, v108
    v_bfi_b32 v109, v123, 0, v109
    v_bfi_b32 v110, v127, 0, v110
    v_bfi_b32 v111, v128, 0, v111
    s_nop 1
    s_waitcnt lgkmcnt(4)
    v_mfma_f32_32x32x16_bf16 v[16:31], v[108:111], v[192:195], v[16:31]
    s_waitcnt lgkmcnt(3)
    v_mfma_f32_32x32x16_bf16 v[32:47], v[108:111], v[196:199], v[32:47]
    v_mfma_f32_32x32x16_bf16 v[48:63], v[100:103], v[160:163], v[48:63]
    v_mfma_f32_32x32x16_bf16 v[64:79], v[100:103], v[164:167], v[64:79]
    s_nop 6
    s_waitcnt lgkmcnt(0)
    v_cvt_pk_bf16_f32 v112, v16, v17
    v_cvt_pk_bf16_f32 v113, v18, v19
    v_cvt_pk_bf16_f32 v114, v20, v21
    v_mfma_f32_32x32x16_bf16 v[80:95], v[100:103], v[168:171], v[80:95]
    v_cvt_pk_bf16_f32 v115, v22, v23
    ds_write_b64 v8, v[112:113] offset:0
    v_cvt_pk_bf16_f32 v116, v24, v25
    v_mfma_f32_32x32x16_bf16 v[48:63], v[104:107], v[180:183], v[48:63]
    v_cvt_pk_bf16_f32 v117, v26, v27
    ds_write_b64 v9, v[114:115] offset:0
    v_cvt_pk_bf16_f32 v118, v28, v29
    v_cvt_pk_bf16_f32 v119, v30, v31
    v_mfma_f32_32x32x16_bf16 v[64:79], v[104:107], v[184:187], v[64:79]
    ds_write_b64 v1, v[116:117] offset:0
    ds_write_b64 v15, v[118:119] offset:0
    v_cvt_pk_bf16_f32 v120, v32, v33
    v_mfma_f32_32x32x16_bf16 v[80:95], v[104:107], v[188:191], v[80:95]
    v_cvt_pk_bf16_f32 v121, v34, v35
    v_cvt_pk_bf16_f32 v122, v36, v37
    v_cvt_pk_bf16_f32 v123, v38, v39
    ds_write_b64 v8, v[120:121] offset:8192
    v_mfma_f32_32x32x16_bf16 v[48:63], v[108:111], v[200:203], v[48:63]
    v_cvt_pk_bf16_f32 v124, v40, v41
    v_cvt_pk_bf16_f32 v125, v42, v43
    ds_write_b64 v9, v[122:123] offset:8192
    v_mfma_f32_32x32x16_bf16 v[64:79], v[108:111], v[204:207], v[64:79]
    v_cvt_pk_bf16_f32 v126, v44, v45
    v_cvt_pk_bf16_f32 v127, v46, v47
    ds_write_b64 v1, v[124:125] offset:8192
    ds_write_b64 v15, v[126:127] offset:8192
    v_mfma_f32_32x32x16_bf16 v[80:95], v[108:111], v[208:211], v[80:95]
    s_waitcnt lgkmcnt(0)
    s_barrier
    s_nop 7
    v_cvt_pk_bf16_f32 v112, v48, v49
    v_cvt_pk_bf16_f32 v113, v50, v51
    v_cvt_pk_bf16_f32 v114, v52, v53
    v_cvt_pk_bf16_f32 v115, v54, v55
    ds_write_b64 v8, v[112:113] offset:16384
    v_cvt_pk_bf16_f32 v116, v56, v57
    v_cvt_pk_bf16_f32 v117, v58, v59
    ds_write_b64 v9, v[114:115] offset:16384
    v_cvt_pk_bf16_f32 v118, v60, v61
    v_cvt_pk_bf16_f32 v119, v62, v63
    ds_write_b64 v1, v[116:117] offset:16384
    ds_write_b64 v15, v[118:119] offset:16384
    v_cvt_pk_bf16_f32 v120, v64, v65
    v_cvt_pk_bf16_f32 v121, v66, v67
    v_cvt_pk_bf16_f32 v122, v68, v69
    v_cvt_pk_bf16_f32 v123, v70, v71
    ds_write_b64 v8, v[120:121] offset:24576
    v_cvt_pk_bf16_f32 v124, v72, v73
    v_cvt_pk_bf16_f32 v125, v74, v75
    ds_write_b64 v9, v[122:123] offset:24576
    v_cvt_pk_bf16_f32 v126, v76, v77
    v_cvt_pk_bf16_f32 v127, v78, v79
    ds_write_b64 v1, v[124:125] offset:24576
    ds_write_b64 v15, v[126:127] offset:24576
    v_cvt_pk_bf16_f32 v112, v80, v81
    v_cvt_pk_bf16_f32 v113, v82, v83
    v_cvt_pk_bf16_f32 v114, v84, v85
    v_cvt_pk_bf16_f32 v115, v86, v87
    ds_write_b64 v8, v[112:113] offset:32768
    v_cvt_pk_bf16_f32 v116, v88, v89
    v_cvt_pk_bf16_f32 v117, v90, v91
    ds_write_b64 v9, v[114:115] offset:32768
    v_cvt_pk_bf16_f32 v118, v92, v93
    v_cvt_pk_bf16_f32 v119, v94, v95
    ds_write_b64 v1, v[116:117] offset:32768
    ds_write_b64 v15, v[118:119] offset:32768
    s_waitcnt lgkmcnt(0)
M_outB:
    s_barrier
    ds_read_b128 v[16:19], v5 offset:16384
    ds_read_b128 v[20:23], v5 offset:24576
    ds_read_b128 v[24:27], v5 offset:32768
    s_add_u32 s43, s44, 73728
    s_waitcnt lgkmcnt(2)
    buffer_store_dwordx4 v[16:19], v6, s[16:19], s43 offen sc0 sc1
    s_add_u32 s43, s44, 110592
    s_waitcnt lgkmcnt(1)
    buffer_store_dwordx4 v[20:23], v6, s[16:19], s43 offen sc0 sc1
    s_add_u32 s43, s44, 147456
    s_waitcnt lgkmcnt(0)
    buffer_store_dwordx4 v[24:27], v6, s[16:19], s43 offen sc0 sc1
    s_endpgm
M_outA:
    v_lshrrev_b32 v7, 4, v2
    s_mul_i32 s44, s37, 4
    s_lshr_b32 s45, s37, 2
    s_mul_i32 s45, s45, 0
    s_add_u32 s44, s44, s45
    v_add_u32 v7, s44, v7
    v_and_b32 v1, 15, v2
    v_and_b32 v15, 7, v7
    v_xor_b32_e64 v15, v15, v1
    v_mul_u32_u24 v3, 256, v7
    v_lshl_add_u32 v3, v15, 4, v3
    v_add_u32 v3, 36864, v3
    v_mul_u32_u24 v4, 1152, v7
    v_lshl_add_u32 v4, v1, 4, v4
    s_add_u32 s44, s39, s35
    v_lshrrev_b32 v7, 4, v2
    s_mul_i32 s44, s38, 4
    s_lshr_b32 s45, s38, 2
    s_mul_i32 s45, s45, 0
    s_add_u32 s44, s44, s45
    v_add_u32 v7, s44, v7
    v_and_b32 v1, 15, v2
    v_and_b32 v15, 7, v7
    v_xor_b32 v15, v15, v1
    v_mul_u32_u24 v5, 256, v7
    v_lshl_add_u32 v5, v15, 4, v5
    v_add_u32 v5, 36864, v5
    v_mul_u32_u24 v6, 1152, v7
    v_lshl_add_u32 v6, v1, 4, v6
    s_add_u32 s44, s39, s35
    s_mov_b32 s16, s10
    s_mov_b32 s17, s11
    s_mov_b32 s18, 9437184
    s_mov_b32 s19, 0x00020000
    s_barrier
    ds_read_b128 v[32:35], v3 offset:0
    ds_read_b128 v[36:39], v3 offset:4096
    ds_read_b128 v[40:43], v3 offset:8192
    ds_read_b128 v[44:47], v3 offset:12288
    s_add_u32 s43, s44, 0
    s_waitcnt lgkmcnt(3)
    buffer_store_dwordx4 v[32:35], v4, s[16:19], s43 offen sc0 sc1
    s_add_u32 s43, s44, 18432
    s_waitcnt lgkmcnt(2)
    buffer_store_dwordx4 v[36:39], v4, s[16:19], s43 offen sc0 sc1
    s_add_u32 s43, s44, 36864
    s_waitcnt lgkmcnt(1)
    buffer_store_dwordx4 v[40:43], v4, s[16:19], s43 offen sc0 sc1
    s_add_u32 s43, s44, 55296
    s_waitcnt lgkmcnt(0)
    buffer_store_dwordx4 v[44:47], v4, s[16:19], s43 offen sc0 sc1
    s_branch M_outB
L_strip:
    s_mul_i32 s34, s32, 43
    s_add_u32 s35, s34, 46
    s_add_u32 s34, s34, 3
    s_lshr_b32 s34, s34, 3
    s_lshr_b32 s35, s35, 3
    s_add_u32 s34, s34, s33
    s_sub_u32 s34, s34, 26
    s_cmp_ge_u32 s34, s35
    s_cbranch_scc1 L_end
    s_mul_i32 s39, s34, 221184
    s_mov_b32 s35, 1024
    s_cmp_ge_u32 s38, 4
    s_cbranch_scc0 S_comp
    v_lshrrev_b32 v3, 3, v2
    v_and_b32 v7, 7, v2
    v_and_b32 v4, 1, v5
    v_lshlrev_b32 v4, 2, v4
    v_xor_b32 v7, v7, v4
    v_mul_u32_u24 v8, 1152, v3
    v_lshl_add_u32 v8, v7, 4, v8
    v_add_u32 v9, 8192, v8
    v_lshrrev_b32 v3, 3, v2
    v_and_b32 v7, 7, v2
    v_mul_u32_u24 v3, 1152, v3
    v_xor_b32 v4, v7, v5
    s_mul_i32 s24, s37, 6
    s_and_b32 s24, s24, 1
    s_lshl_b32 s24, s24, 2
    v_xor_b32 v4, s24, v4
    v_xor_b32 v7, 4, v4
    v_lshl_add_u32 v12, v4, 4, v3
    v_lshl_add_u32 v13, v7, 4, v3
    v_add_u32 v13, 8192, v13
    v_add_u32 v14, 16384, v12
    v_add_u32 v15, 16384, v13
    s_mul_i32 s24, s37, 55296
    s_add_u32 s24, s24, s39
    s_mov_b32 s26, s24
    s_mov_b32 s14, 9437184
    s_mov_b32 s15, 0x00020000
    s_mul_i32 s22, s37, 18432
    s_add_u32 s22, s22, s35
    s_mov_b32 s40, s22
    s_mul_i32 s27, s37, 2048
    s_mov_b32 m0, s27
    s_mul_i32 s28, s37, 6144
    s_add_u32 s28, s28, 8192
    s_mov_b32 s18, 663552
    s_mov_b32 s19, 0x00020000
    s_waitcnt lgkmcnt(0)
    s_mov_b32 s16, s6
    s_mov_b32 s17, s7
    buffer_load_dwordx4 v8, s[16:19], s40 offen offset:0 lds
    buffer_load_dwordx4 v9, s[16:19], s40 offen offset:1024 lds
    s_add_u32 s40, s40, 73728
    s_mov_b32 s12, s4
    s_mov_b32 s13, s5
    s_add_u32 m0, s28, 0
    s_add_u32 s41, s26, 36864
    buffer_load_dwordx4 v12, s[12:15], s26 offen offset:0  lds
    buffer_load_dwordx4 v13, s[12:15], s26 offen offset:1024  lds
    buffer_load_dwordx4 v14, s[12:15], s26 offen offset:2048  lds
    buffer_load_dwordx4 v15, s[12:15], s26 offen offset:3072  lds
    s_add_u32 m0, s28, 4096
    s_add_u32 s26, s26, 128
    buffer_load_dwordx4 v12, s[12:15], s41 offen offset:0  lds
    buffer_load_dwordx4 v13, s[12:15], s41 offen offset:1024  lds
    s_add_u32 m0, s27, 32768
    s_nop 0
    buffer_load_dwordx4 v8, s[16:19], s40 offen offset:0 lds
    buffer_load_dwordx4 v9, s[16:19], s40 offen offset:1024 lds
    s_add_u32 s40, s40, 73728
    s_add_u32 m0, s28, 32768
    s_add_u32 s41, s26, 36864
    buffer_load_dwordx4 v12, s[12:15], s26 offen offset:0  lds
    buffer_load_dwordx4 v13, s[12:15], s26 offen offset:1024  lds
    buffer_load_dwordx4 v14, s[12:15], s26 offen offset:2048  lds
    buffer_load_dwordx4 v15, s[12:15], s26 offen offset:3072  lds
    s_add_u32 m0, s28, 36864
    s_add_u32 s26, s26, 128
    buffer_load_dwordx4 v12, s[12:15], s41 offen offset:0  lds
    buffer_load_dwordx4 v13, s[12:15], s41 offen offset:1024  lds
    s_waitcnt vmcnt(8)
    s_barrier
    s_add_u32 m0, s27, 65536
    s_nop 0
    buffer_load_dwordx4 v8, s[16:19], s40 offen offset:0 lds
    buffer_load_dwordx4 v9, s[16:19], s40 offen offset:1024 lds
    s_add_u32 s40, s40, 73728
    s_add_u32 m0, s28, 65536
    s_add_u32 s41, s26, 36864
    buffer_load_dwordx4 v12, s[12:15], s26 offen offset:0  lds
    buffer_load_dwordx4 v13, s[12:15], s26 offen offset:1024  lds
    buffer_load_dwordx4 v14, s[12:15], s26 offen offset:2048  lds
    buffer_load_dwordx4 v15, s[12:15], s26 offen offset:3072  lds
    s_add_u32 m0, s28, 69632
    s_add_u32 s26, s26, 128
    buffer_load_dwordx4 v12, s[12:15], s41 offen offset:0  lds
    buffer_load_dwordx4 v13, s[12:15], s41 offen offset:1024  lds
    s_waitcnt vmcnt(8)
    s_barrier
    s_add_u32 m0, s27, 98304
    s_nop 0
    buffer_load_dwordx4 v8, s[16:19], s40 offen offset:0 lds
    buffer_load_dwordx4 v9, s[16:19], s40 offen offset:1024 lds
    s_add_u32 s40, s40, 73728
    s_add_u32 m0, s28, 98304
    s_add_u32 s41, s26, 36864
    buffer_load_dwordx4 v12, s[12:15], s26 offen offset:0  lds
    buffer_load_dwordx4 v13, s[12:15], s26 offen offset:1024  lds
    buffer_load_dwordx4 v14, s[12:15], s26 offen offset:2048  lds
    buffer_load_dwordx4 v15, s[12:15], s26 offen offset:3072  lds
    s_add_u32 m0, s28, 102400
    s_add_u32 s26, s26, 128
    buffer_load_dwordx4 v12, s[12:15], s41 offen offset:0  lds
    buffer_load_dwordx4 v13, s[12:15], s41 offen offset:1024  lds
    s_add_u32 m0, s27, 0
    s_nop 0
    buffer_load_dwordx4 v8, s[16:19], s40 offen offset:0 lds
    buffer_load_dwordx4 v9, s[16:19], s40 offen offset:1024 lds
    s_add_u32 s40, s40, 73728
    s_waitcnt vmcnt(10)
    s_barrier
    s_add_u32 m0, s28, 0
    s_add_u32 s41, s26, 36864
    buffer_load_dwordx4 v12, s[12:15], s26 offen offset:0  lds
    buffer_load_dwordx4 v13, s[12:15], s26 offen offset:1024  lds
    buffer_load_dwordx4 v14, s[12:15], s26 offen offset:2048  lds
    buffer_load_dwordx4 v15, s[12:15], s26 offen offset:3072  lds
    s_add_u32 m0, s28, 4096
    s_add_u32 s26, s26, 128
    buffer_load_dwordx4 v12, s[12:15], s41 offen offset:0  lds
    buffer_load_dwordx4 v13, s[12:15], s41 offen offset:1024  lds
    s_add_u32 m0, s27, 32768
    s_nop 0
    buffer_load_dwordx4 v8, s[16:19], s40 offen offset:0 lds
    buffer_load_dwordx4 v9, s[16:19], s40 offen offset:1024 lds
    s_add_u32 s40, s40, 73728
    s_waitcnt vmcnt(10)
    s_barrier
    s_add_u32 m0, s28, 32768
    s_add_u32 s41, s26, 36864
    buffer_load_dwordx4 v12, s[12:15], s26 offen offset:0  lds
    buffer_load_dwordx4 v13, s[12:15], s26 offen offset:1024  lds
    buffer_load_dwordx4 v14, s[12:15], s26 offen offset:2048  lds
    buffer_load_dwordx4 v15, s[12:15], s26 offen offset:3072  lds
    s_add_u32 m0, s28, 36864
    s_add_u32 s26, s26, 128
    buffer_load_dwordx4 v12, s[12:15], s41 offen offset:0  lds
    buffer_load_dwordx4 v13, s[12:15], s41 offen offset:1024  lds
    s_add_u32 m0, s27, 65536
    s_nop 0
    buffer_load_dwordx4 v8, s[16:19], s40 offen offset:0 lds
    buffer_load_dwordx4 v9, s[16:19], s40 offen offset:1024 lds
    s_add_u32 s40, s40, 73728
    s_waitcnt vmcnt(10)
    s_barrier
    s_add_u32 m0, s28, 65536
    s_add_u32 s41, s26, 36864
    buffer_load_dwordx4 v12, s[12:15], s26 offen offset:0  lds
    buffer_load_dwordx4 v13, s[12:15], s26 offen offset:1024  lds
    buffer_load_dwordx4 v14, s[12:15], s26 offen offset:2048  lds
    buffer_load_dwordx4 v15, s[12:15], s26 offen offset:3072  lds
    s_add_u32 m0, s28, 69632
    s_add_u32 s26, s26, 128
    buffer_load_dwordx4 v12, s[12:15], s41 offen offset:0  lds
    buffer_load_dwordx4 v13, s[12:15], s41 offen offset:1024  lds
    s_add_u32 m0, s27, 98304
    s_nop 0
    buffer_load_dwordx4 v8, s[16:19], s40 offen offset:0 lds
    buffer_load_dwordx4 v9, s[16:19], s40 offen offset:1024 lds
    s_add_u32 s40, s40, 73728
    s_waitcnt vmcnt(10)
    s_barrier
    s_add_u32 m0, s28, 98304
    s_add_u32 s41, s26, 36864
    buffer_load_dwordx4 v12, s[12:15], s26 offen offset:0  lds
    buffer_load_dwordx4 v13, s[12:15], s26 offen offset:1024  lds
    buffer_load_dwordx4 v14, s[12:15], s26 offen offset:2048  lds
    buffer_load_dwordx4 v15, s[12:15], s26 offen offset:3072  lds
    s_add_u32 m0, s28, 102400
    s_add_u32 s26, s26, 128
    buffer_load_dwordx4 v12, s[12:15], s41 offen offset:0  lds
    buffer_load_dwordx4 v13, s[12:15], s41 offen offset:1024  lds
    s_add_u32 m0, s27, 0
    s_nop 0
    buffer_load_dwordx4 v8, s[16:19], s40 offen offset:0 lds
    buffer_load_dwordx4 v9, s[16:19], s40 offen offset:1024 lds
    s_add_u32 s40, s40, 73728
    s_waitcnt vmcnt(10)
    s_barrier
    s_add_u32 m0, s28, 0
    s_add_u32 s41, s26, 36864
    buffer_load_dwordx4 v12, s[12:15], s26 offen offset:0  lds
    buffer_load_dwordx4 v13, s[12:15], s26 offen offset:1024  lds
    buffer_load_dwordx4 v14, s[12:15], s26 offen offset:2048  lds
    buffer_load_dwordx4 v15, s[12:15], s26 offen offset:3072  lds
    s_add_u32 m0, s28, 4096
    s_add_u32 s26, s26, 128
    buffer_load_dwordx4 v12, s[12:15], s41 offen offset:0  lds
    buffer_load_dwordx4 v13, s[12:15], s41 offen offset:1024  lds
    s_waitcnt vmcnt(8)
    s_barrier
    s_waitcnt vmcnt(0)
    s_barrier
    s_branch S_outA
S_comp:
    s_and_b32 s40, s37, 1
    s_lshr_b32 s41, s37, 1
    s_mul_i32 s41, s41, 96
    v_and_b32 v3, 31, v2
    v_lshrrev_b32 v4, 5, v2
    s_lshl_b32 s42, s40, 6
    s_add_u32 s42, s42, s35
    v_lshlrev_b32 v7, 3, v4
    v_add_u32 v7, s42, v7
    s_mov_b32 s20, 0x7fff7fff
    s_mov_b32 s21, 0x000f000f
    s_waitcnt lgkmcnt(0)
    s_mov_b32 s12, s8
    s_mov_b32 s13, s9
    s_mov_b32 s14, 1152
    s_mov_b32 s15, 0x00020000
    buffer_load_dwordx2 v[100:101], v7, s[12:15], 0 offen offset:0
    buffer_load_dwordx2 v[102:103], v7, s[12:15], 0 offen offset:16
    buffer_load_dwordx2 v[104:105], v7, s[12:15], 0 offen offset:32
    buffer_load_dwordx2 v[106:107], v7, s[12:15], 0 offen offset:48
    v_add_u32 v7, s41, v3
    v_bfe_u32 v8, v7, 1, 3
    v_xor_b32 v8, v8, v4
    v_lshlrev_b32 v7, 7, v7
    v_add_u32 v7, 8192, v7
    v_lshl_add_u32 v10, v8, 4, v7
    v_xor_b32_e64 v9, 2, v8
    v_lshl_add_u32 v11, v9, 4, v7
    v_xor_b32_e64 v9, 4, v8
    v_lshl_add_u32 v12, v9, 4, v7
    v_xor_b32_e64 v9, 6, v8
    v_lshl_add_u32 v13, v9, 4, v7
    v_lshrrev_b32_e64 v7, 2, v6
    v_lshl_add_u32 v8, v4, 3, v7
    v_mul_u32_u24 v8, 128, v8
    v_and_b32_e64 v9, 1, v5
    v_lshl_add_u32 v8, v9, 5, v8
    v_and_b32_e64 v9, 3, v6
    v_lshl_add_u32 v8, v9, 3, v8
    v_lshrrev_b32 v9, 1, v7
    v_xor_b32 v9, s40, v9
    v_lshl_add_u32 v14, v9, 6, v8
    v_add_u32 v7, s41, v3
    v_and_b32 v15, 7, v7
    v_xor_b32 v15, v15, v4
    s_lshl_b32 s42, s40, 2
    v_xor_b32_e64 v15, s42, v15
    v_mul_u32_u24 v7, 128, v7
    v_add_u32 v7, 32768, v7
    v_lshl_add_u32 v8, v15, 4, v7
    v_xor_b32_e64 v15, 2, v15
    v_lshl_add_u32 v9, v15, 4, v7
    v_lshrrev_b32_e64 v7, 3, v2
    s_mul_i32 s44, s37, 8
    s_lshr_b32 s45, s38, 2
    s_mul_i32 s45, s45, 96
    s_add_u32 s44, s44, s45
    v_add_u32 v7, s44, v7
    v_and_b32 v1, 7, v2
    v_and_b32 v15, 7, v7
    v_xor_b32_e64 v15, v15, v1
    v_mul_u32_u24 v5, 128, v7
    v_lshl_add_u32 v5, v15, 4, v5
    v_add_u32 v5, 32768, v5
    v_mul_u32_u24 v6, 1152, v7
    v_lshl_add_u32 v6, v1, 4, v6
    s_add_u32 s44, s39, s35
    s_mov_b32 s16, s10
    s_mov_b32 s17, s11
    s_mov_b32 s18, 9437184
    s_mov_b32 s19, 0x00020000
    v_add_u32 v7, s41, v3
    v_and_b32 v15, 7, v7
    s_lshl_b32 s42, s40, 2
    v_xor_b32_e64 v15, s42, v15
    v_mul_u32_u24 v7, 128, v7
    v_lshl_add_u32 v7, v4, 3, v7
    v_add_u32 v7, 32768, v7
    v_lshl_add_u32 v8, v15, 4, v7
    v_xor_b32 v9, 16, v8
    v_xor_b32 v1, 32, v8
    v_xor_b32 v15, 48, v8
    s_mov_b32 s50, 0
    s_mov_b32 s53, 32768
    s_mov_b32 s51, 4294901760
    s_waitcnt vmcnt(0)
    v_lshlrev_b32 v16, 16, v100
    v_and_b32 v17, 0xffff0000, v100
    v_lshlrev_b32_e64 v18, 16, v101
    v_and_b32 v19, 0xffff0000, v101
    v_lshlrev_b32_e64 v20, 16, v102
    v_and_b32 v21, 0xffff0000, v102
    v_lshlrev_b32_e64 v22, 16, v103
    v_and_b32 v23, 0xffff0000, v103
    v_lshlrev_b32_e64 v24, 16, v104
    v_and_b32 v25, 0xffff0000, v104
    v_lshlrev_b32_e64 v26, 16, v105
    v_and_b32 v27, 0xffff0000, v105
    v_lshlrev_b32_e64 v28, 16, v106
    v_and_b32 v29, 0xffff0000, v106
    v_lshlrev_b32_e64 v30, 16, v107
    v_and_b32 v31, 0xffff0000, v107
    v_mov_b64 v[32:33], v[16:17]
    v_mov_b64 v[34:35], v[18:19]
    v_mov_b64 v[36:37], v[20:21]
    v_mov_b64 v[38:39], v[22:23]
    v_mov_b64 v[40:41], v[24:25]
    v_mov_b64 v[42:43], v[26:27]
    v_mov_b64 v[44:45], v[28:29]
    v_mov_b64 v[46:47], v[30:31]
    v_mov_b64 v[48:49], v[16:17]
    v_mov_b64 v[50:51], v[18:19]
    v_mov_b64 v[52:53], v[20:21]
    v_mov_b64 v[54:55], v[22:23]
    v_mov_b64 v[56:57], v[24:25]
    v_mov_b64 v[58:59], v[26:27]
    v_mov_b64 v[60:61], v[28:29]
    v_mov_b64 v[62:63], v[30:31]
    s_setprio 1
    s_barrier
    ds_read_b64_tr_b16 v[64:65], v14 offset:0
    ds_read_b64_tr_b16 v[66:67], v14 offset:512
    ds_read_b128 v[100:103], v10 offset:0
    ds_read_b128 v[104:107], v10 offset:4096
    ds_read_b128 v[108:111], v10 offset:8192
    ds_read_b64_tr_b16 v[68:69], v14 offset:2048
    ds_read_b64_tr_b16 v[70:71], v14 offset:2560
    ds_read_b128 v[112:115], v11 offset:0
    ds_read_b128 v[116:119], v11 offset:4096
    ds_read_b128 v[120:123], v11 offset:8192
    ds_read_b64_tr_b16 v[72:73], v14 offset:4096
    ds_read_b64_tr_b16 v[74:75], v14 offset:4608
    ds_read_b128 v[124:127], v12 offset:0
    ds_read_b128 v[128:131], v12 offset:4096
    ds_read_b128 v[132:135], v12 offset:8192
    s_waitcnt lgkmcnt(13)
    v_and_b32 v80, s20, v64
    v_and_b32 v81, s20, v65
    v_and_b32 v85, s20, v66
    v_and_b32_e64 v86, s20, v67
    v_pk_max_u16 v82, v80, v81
    v_pk_min_u16 v83, v80, v81
    v_pk_max_u16 v87, v85, v86
    v_pk_min_u16 v88, v85, v86
    v_pk_min_u16 v82, v82, v82 op_sel:[0,1] op_sel_hi:[1,0]
    v_pk_max_u16 v83, v83, v83 op_sel:[0,1] op_sel_hi:[1,0]
    v_pk_min_u16 v87, v87, v87 op_sel:[0,1] op_sel_hi:[1,0]
    v_pk_max_u16 v88, v88, v88 op_sel:[0,1] op_sel_hi:[1,0]
    v_pk_max_u16 v82, v82, v83
    v_pk_max_u16 v87, v87, v88
    v_pk_sub_i16 v80, v80, v82
    v_pk_sub_i16 v81, v81, v82
    v_pk_sub_i16 v85, v85, v87
    v_pk_sub_i16 v86, v86, v87
    v_pk_ashrrev_i16 v80, s21, v80
    v_pk_ashrrev_i16 v81, s21, v81
    v_pk_ashrrev_i16 v85, s21, v85
    v_pk_ashrrev_i16 v86, s21, v86
    v_bfi_b32 v64, v80, 0, v64
    v_bfi_b32 v65, v81, 0, v65
    v_bfi_b32 v66, v85, 0, v66
    v_bfi_b32 v67, v86, 0, v67
    s_waitcnt lgkmcnt(8)
    v_and_b32 v90, s20, v68
    v_and_b32 v91, s20, v69
    v_and_b32 v95, s20, v70
    v_and_b32_e64 v96, s20, v71
    v_pk_max_u16 v92, v90, v91
    v_pk_min_u16 v93, v90, v91
    v_pk_max_u16 v97, v95, v96
    v_pk_min_u16 v98, v95, v96
    v_pk_min_u16 v92, v92, v92 op_sel:[0,1] op_sel_hi:[1,0]
    v_pk_max_u16 v93, v93, v93 op_sel:[0,1] op_sel_hi:[1,0]
    v_pk_min_u16 v97, v97, v97 op_sel:[0,1] op_sel_hi:[1,0]
    v_pk_max_u16 v98, v98, v98 op_sel:[0,1] op_sel_hi:[1,0]
    v_pk_max_u16 v92, v92, v93
    v_pk_max_u16 v97, v97, v98
S_loop:
    s_waitcnt lgkmcnt(3)
    v_and_b32 v80, s20, v72
    v_mfma_f32_32x32x16_bf16 v[16:31], v[64:67], v[100:103], v[16:31]
    ds_read_b64_tr_b16 v[76:77], v14 offset:6144
    ds_read_b64_tr_b16 v[78:79], v14 offset:6656
    ds_read_b128 v[136:139], v13 offset:0
    v_pk_sub_i16 v90, v90, v92
    v_and_b32_e64 v81, s20, v73
    v_pk_sub_i16 v91, v91, v92
    v_and_b32_e64 v85, s20, v74
    v_pk_sub_i16 v95, v95, v97
    v_and_b32_e64 v86, s20, v75
    v_pk_sub_i16 v96, v96, v97
    v_mfma_f32_32x32x16_bf16 v[32:47], v[64:67], v[104:107], v[32:47]
    ds_read_b128 v[140:143], v13 offset:4096
    ds_read_b128 v[144:147], v13 offset:8192
    v_pk_ashrrev_i16 v90, s21, v90
    v_pk_max_u16 v82, v80, v81
    v_pk_ashrrev_i16 v91, s21, v91
    v_pk_min_u16 v83, v80, v81
    v_pk_ashrrev_i16 v95, s21, v95
    v_pk_max_u16 v87, v85, v86
    v_pk_ashrrev_i16 v96, s21, v96
    v_bfi_b32 v68, v90, 0, v68
    v_mfma_f32_32x32x16_bf16 v[48:63], v[64:67], v[108:111], v[48:63]
    v_pk_min_u16 v88, v85, v86
    v_bfi_b32 v69, v91, 0, v69
    v_pk_min_u16 v82, v82, v82 op_sel:[0,1] op_sel_hi:[1,0]
    v_bfi_b32 v70, v95, 0, v70
    v_pk_max_u16 v83, v83, v83 op_sel:[0,1] op_sel_hi:[1,0]
    v_bfi_b32 v71, v96, 0, v71
    v_pk_min_u16 v87, v87, v87 op_sel:[0,1] op_sel_hi:[1,0]
    v_pk_max_u16 v88, v88, v88 op_sel:[0,1] op_sel_hi:[1,0]
    v_pk_max_u16 v82, v82, v83
    v_pk_max_u16 v87, v87, v88
    s_waitcnt lgkmcnt(3)
    v_and_b32 v90, s20, v76
    v_mfma_f32_32x32x16_bf16 v[16:31], v[68:71], v[112:115], v[16:31]
    v_pk_sub_i16 v80, v80, v82
    v_and_b32_e64 v91, s20, v77
    v_pk_sub_i16 v81, v81, v82
    v_and_b32_e64 v95, s20, v78
    v_pk_sub_i16 v85, v85, v87
    v_and_b32_e64 v96, s20, v79
    v_pk_sub_i16 v86, v86, v87
    v_pk_ashrrev_i16 v80, s21, v80
    v_pk_max_u16 v92, v90, v91
    v_pk_ashrrev_i16 v81, s21, v81
    s_waitcnt lgkmcnt(0)
    s_barrier
S_nobar0:
    v_mfma_f32_32x32x16_bf16 v[32:47], v[68:71], v[116:119], v[32:47]
    ds_read_b64_tr_b16 v[64:65], v14 offset:32768
    ds_read_b64_tr_b16 v[66:67], v14 offset:33280
    ds_read_b128 v[100:103], v10 offset:32768
    v_pk_min_u16 v93, v90, v91
    v_pk_ashrrev_i16 v85, s21, v85
    v_pk_max_u16 v97, v95, v96
    v_pk_ashrrev_i16 v86, s21, v86
    v_bfi_b32 v72, v80, 0, v72
    v_pk_min_u16 v98, v95, v96
    v_bfi_b32 v73, v81, 0, v73
    v_mfma_f32_32x32x16_bf16 v[48:63], v[68:71], v[120:123], v[48:63]
    ds_read_b128 v[104:107], v10 offset:36864
    ds_read_b128 v[108:111], v10 offset:40960
    v_pk_min_u16 v92, v92, v92 op_sel:[0,1] op_sel_hi:[1,0]
    v_bfi_b32 v74, v85, 0, v74
    v_pk_max_u16 v93, v93, v93 op_sel:[0,1] op_sel_hi:[1,0]
    v_bfi_b32 v75, v86, 0, v75
    v_pk_min_u16 v97, v97, v97 op_sel:[0,1] op_sel_hi:[1,0]
    v_pk_max_u16 v98, v98, v98 op_sel:[0,1] op_sel_hi:[1,0]
    v_pk_max_u16 v92, v92, v93
    v_pk_max_u16 v97, v97, v98
    s_waitcnt lgkmcnt(3)
    v_and_b32 v80, s20, v64
    v_mfma_f32_32x32x16_bf16 v[16:31], v[72:75], v[124:127], v[16:31]
    ds_read_b64_tr_b16 v[68:69], v14 offset:34816
    ds_read_b64_tr_b16 v[70:71], v14 offset:35328
    v_pk_sub_i16 v90, v90, v92
    v_and_b32_e64 v81, s20, v65
    v_pk_sub_i16 v91, v91, v92
    v_and_b32_e64 v85, s20, v66
    v_pk_sub_i16 v95, v95, v97
    v_and_b32_e64 v86, s20, v67
    v_pk_sub_i16 v96, v96, v97
    v_pk_ashrrev_i16 v90, s21, v90
    v_mfma_f32_32x32x16_bf16 v[32:47], v[72:75], v[128:131], v[32:47]
    ds_read_b128 v[112:115], v11 offset:32768
    ds_read_b128 v[116:119], v11 offset:36864
    v_pk_max_u16 v82, v80, v81
    v_pk_ashrrev_i16 v91, s21, v91
    v_pk_min_u16 v83, v80, v81
    v_pk_ashrrev_i16 v95, s21, v95
    v_pk_max_u16 v87, v85, v86
    v_pk_ashrrev_i16 v96, s21, v96
    v_bfi_b32 v76, v90, 0, v76
    v_pk_min_u16 v88, v85, v86
    v_mfma_f32_32x32x16_bf16 v[48:63], v[72:75], v[132:135], v[48:63]
    ds_read_b128 v[120:123], v11 offset:40960
    v_bfi_b32 v77, v91, 0, v77
    v_pk_min_u16 v82, v82, v82 op_sel:[0,1] op_sel_hi:[1,0]
    v_bfi_b32 v78, v95, 0, v78
    v_pk_max_u16 v83, v83, v83 op_sel:[0,1] op_sel_hi:[1,0]
    v_bfi_b32 v79, v96, 0, v79
    v_pk_min_u16 v87, v87, v87 op_sel:[0,1] op_sel_hi:[1,0]
    v_pk_max_u16 v88, v88, v88 op_sel:[0,1] op_sel_hi:[1,0]
    v_pk_max_u16 v82, v82, v83
    v_pk_max_u16 v87, v87, v88
    s_waitcnt lgkmcnt(3)
    v_and_b32 v90, s20, v68
    v_mfma_f32_32x32x16_bf16 v[16:31], v[76:79], v[136:139], v[16:31]
    ds_read_b64_tr_b16 v[72:73], v14 offset:36864
    ds_read_b64_tr_b16 v[74:75], v14 offset:37376
    v_pk_sub_i16 v80, v80, v82
    v_and_b32_e64 v91, s20, v69
    v_pk_sub_i16 v81, v81, v82
    v_and_b32_e64 v95, s20, v70
    v_pk_sub_i16 v85, v85, v87
    v_and_b32_e64 v96, s20, v71
    v_pk_sub_i16 v86, v86, v87
    v_pk_ashrrev_i16 v80, s21, v80
    v_mfma_f32_32x32x16_bf16 v[32:47], v[76:79], v[140:143], v[32:47]
    ds_read_b128 v[124:127], v12 offset:32768
    ds_read_b128 v[128:131], v12 offset:36864
    v_pk_max_u16 v92, v90, v91
    v_pk_ashrrev_i16 v81, s21, v81
    v_pk_min_u16 v93, v90, v91
    v_pk_ashrrev_i16 v85, s21, v85
    v_pk_max_u16 v97, v95, v96
    v_pk_ashrrev_i16 v86, s21, v86
    v_bfi_b32 v64, v80, 0, v64
    v_pk_min_u16 v98, v95, v96
    v_mfma_f32_32x32x16_bf16 v[48:63], v[76:79], v[144:147], v[48:63]
    ds_read_b128 v[132:135], v12 offset:40960
    v_bfi_b32 v65, v81, 0, v65
    v_pk_min_u16 v92, v92, v92 op_sel:[0,1] op_sel_hi:[1,0]
    v_bfi_b32 v66, v85, 0, v66
    v_pk_max_u16 v93, v93, v93 op_sel:[0,1] op_sel_hi:[1,0]
    v_bfi_b32 v67, v86, 0, v67
    v_pk_min_u16 v97, v97, v97 op_sel:[0,1] op_sel_hi:[1,0]
    v_pk_max_u16 v98, v98, v98 op_sel:[0,1] op_sel_hi:[1,0]
    v_pk_max_u16 v92, v92, v93
    v_pk_max_u16 v97, v97, v98
    s_waitcnt lgkmcnt(3)
    v_and_b32 v80, s20, v72
    v_mfma_f32_32x32x16_bf16 v[16:31], v[64:67], v[100:103], v[16:31]
    ds_read_b64_tr_b16 v[76:77], v14 offset:38912
    ds_read_b64_tr_b16 v[78:79], v14 offset:39424
    ds_read_b128 v[136:139], v13 offset:32768
    v_pk_sub_i16 v90, v90, v92
    v_and_b32_e64 v81, s20, v73
    v_pk_sub_i16 v91, v91, v92
    v_and_b32_e64 v85, s20, v74
    v_pk_sub_i16 v95, v95, v97
    v_and_b32_e64 v86, s20, v75
    v_pk_sub_i16 v96, v96, v97
    v_mfma_f32_32x32x16_bf16 v[32:47], v[64:67], v[104:107], v[32:47]
    ds_read_b128 v[140:143], v13 offset:36864
    ds_read_b128 v[144:147], v13 offset:40960
    v_pk_ashrrev_i16 v90, s21, v90
    v_pk_max_u16 v82, v80, v81
    v_pk_ashrrev_i16 v91, s21, v91
    v_pk_min_u16 v83, v80, v81
    v_pk_ashrrev_i16 v95, s21, v95
    v_pk_max_u16 v87, v85, v86
    v_pk_ashrrev_i16 v96, s21, v96
    v_bfi_b32 v68, v90, 0, v68
    v_mfma_f32_32x32x16_bf16 v[48:63], v[64:67], v[108:111], v[48:63]
    v_pk_min_u16 v88, v85, v86
    v_bfi_b32 v69, v91, 0, v69
    v_pk_min_u16 v82, v82, v82 op_sel:[0,1] op_sel_hi:[1,0]
    v_bfi_b32 v70, v95, 0, v70
    v_pk_max_u16 v83, v83, v83 op_sel:[0,1] op_sel_hi:[1,0]
    v_bfi_b32 v71, v96, 0, v71
    v_pk_min_u16 v87, v87, v87 op_sel:[0,1] op_sel_hi:[1,0]
    v_pk_max_u16 v88, v88, v88 op_sel:[0,1] op_sel_hi:[1,0]
    v_pk_max_u16 v82, v82, v83
    v_pk_max_u16 v87, v87, v88
    s_add_u32 s50, s50, 1
    s_sub_u32 s51, 0, s51
    v_add_u32 v14, s51, v14
    v_add_u32 v10, s51, v10
    s_waitcnt lgkmcnt(3)
    v_and_b32 v90, s20, v76
    v_mfma_f32_32x32x16_bf16 v[16:31], v[68:71], v[112:115], v[16:31]
    v_pk_sub_i16 v80, v80, v82
    v_and_b32_e64 v91, s20, v77
    v_pk_sub_i16 v81, v81, v82
    v_and_b32_e64 v95, s20, v78
    v_pk_sub_i16 v85, v85, v87
    v_and_b32_e64 v96, s20, v79
    v_pk_sub_i16 v86, v86, v87
    v_pk_ashrrev_i16 v80, s21, v80
    v_pk_max_u16 v92, v90, v91
    v_pk_ashrrev_i16 v81, s21, v81
    v_add_u32_e64 v13, s51, v13
    s_waitcnt lgkmcnt(0)
    s_barrier
S_nobar1:
    v_mfma_f32_32x32x16_bf16 v[32:47], v[68:71], v[116:119], v[32:47]
    ds_read_b64_tr_b16 v[64:65], v14 offset:0
    ds_read_b64_tr_b16 v[66:67], v14 offset:512
    ds_read_b128 v[100:103], v10 offset:0
    v_pk_min_u16 v93, v90, v91
    v_pk_ashrrev_i16 v85, s21, v85
    v_pk_max_u16 v97, v95, v96
    v_pk_ashrrev_i16 v86, s21, v86
    v_bfi_b32 v72, v80, 0, v72
    v_pk_min_u16 v98, v95, v96
    v_bfi_b32 v73, v81, 0, v73
    v_mfma_f32_32x32x16_bf16 v[48:63], v[68:71], v[120:123], v[48:63]
    ds_read_b128 v[104:107], v10 offset:4096
    ds_read_b128 v[108:111], v10 offset:8192
    v_pk_min_u16 v92, v92, v92 op_sel:[0,1] op_sel_hi:[1,0]
    v_bfi_b32 v74, v85, 0, v74
    v_pk_max_u16 v93, v93, v93 op_sel:[0,1] op_sel_hi:[1,0]
    v_bfi_b32 v75, v86, 0, v75
    v_pk_min_u16 v97, v97, v97 op_sel:[0,1] op_sel_hi:[1,0]
    v_pk_max_u16 v98, v98, v98 op_sel:[0,1] op_sel_hi:[1,0]
    v_pk_max_u16 v92, v92, v93
    v_pk_max_u16 v97, v97, v98
    v_add_u32 v11, s51, v11
    s_waitcnt lgkmcnt(3)
    v_and_b32_e64 v80, s20, v64
    v_mfma_f32_32x32x16_bf16 v[16:31], v[72:75], v[124:127], v[16:31]
    ds_read_b64_tr_b16 v[68:69], v14 offset:2048
    ds_read_b64_tr_b16 v[70:71], v14 offset:2560
    v_pk_sub_i16 v90, v90, v92
    v_and_b32_e64 v81, s20, v65
    v_pk_sub_i16 v91, v91, v92
    v_and_b32_e64 v85, s20, v66
    v_pk_sub_i16 v95, v95, v97
    v_and_b32_e64 v86, s20, v67
    v_pk_sub_i16 v96, v96, v97
    v_pk_ashrrev_i16 v90, s21, v90
    v_mfma_f32_32x32x16_bf16 v[32:47], v[72:75], v[128:131], v[32:47]
    ds_read_b128 v[112:115], v11 offset:0
    ds_read_b128 v[116:119], v11 offset:4096
    v_pk_max_u16 v82, v80, v81
    v_pk_ashrrev_i16 v91, s21, v91
    v_pk_min_u16 v83, v80, v81
    v_pk_ashrrev_i16 v95, s21, v95
    v_pk_max_u16 v87, v85, v86
    v_pk_ashrrev_i16 v96, s21, v96
    v_bfi_b32 v76, v90, 0, v76
    v_pk_min_u16 v88, v85, v86
    v_mfma_f32_32x32x16_bf16 v[48:63], v[72:75], v[132:135], v[48:63]
    ds_read_b128 v[120:123], v11 offset:8192
    v_bfi_b32 v77, v91, 0, v77
    v_pk_min_u16 v82, v82, v82 op_sel:[0,1] op_sel_hi:[1,0]
    v_bfi_b32 v78, v95, 0, v78
    v_pk_max_u16 v83, v83, v83 op_sel:[0,1] op_sel_hi:[1,0]
    v_bfi_b32 v79, v96, 0, v79
    v_pk_min_u16 v87, v87, v87 op_sel:[0,1] op_sel_hi:[1,0]
    v_pk_max_u16 v88, v88, v88 op_sel:[0,1] op_sel_hi:[1,0]
    v_pk_max_u16 v82, v82, v83
    v_pk_max_u16 v87, v87, v88
    v_add_u32 v12, s51, v12
    s_waitcnt lgkmcnt(3)
    v_and_b32_e64 v90, s20, v68
    v_mfma_f32_32x32x16_bf16 v[16:31], v[76:79], v[136:139], v[16:31]
    ds_read_b64_tr_b16 v[72:73], v14 offset:4096
    ds_read_b64_tr_b16 v[74:75], v14 offset:4608
    v_pk_sub_i16 v80, v80, v82
    v_and_b32_e64 v91, s20, v69
    v_pk_sub_i16 v81, v81, v82
    v_and_b32_e64 v95, s20, v70
    v_pk_sub_i16 v85, v85, v87
    v_and_b32_e64 v96, s20, v71
    v_pk_sub_i16 v86, v86, v87
    v_pk_ashrrev_i16 v80, s21, v80
    v_mfma_f32_32x32x16_bf16 v[32:47], v[76:79], v[140:143], v[32:47]
    ds_read_b128 v[124:127], v12 offset:0
    ds_read_b128 v[128:131], v12 offset:4096
    v_pk_max_u16 v92, v90, v91
    v_pk_ashrrev_i16 v81, s21, v81
    v_pk_min_u16 v93, v90, v91
    v_pk_ashrrev_i16 v85, s21, v85
    v_pk_max_u16 v97, v95, v96
    v_pk_ashrrev_i16 v86, s21, v86
    v_bfi_b32 v64, v80, 0, v64
    v_pk_min_u16 v98, v95, v96
    v_mfma_f32_32x32x16_bf16 v[48:63], v[76:79], v[144:147], v[48:63]
    ds_read_b128 v[132:135], v12 offset:8192
    v_bfi_b32 v65, v81, 0, v65
    v_pk_min_u16 v92, v92, v92 op_sel:[0,1] op_sel_hi:[1,0]
    v_bfi_b32 v66, v85, 0, v66
    v_pk_max_u16 v93, v93, v93 op_sel:[0,1] op_sel_hi:[1,0]
    v_bfi_b32 v67, v86, 0, v67
    v_pk_min_u16 v97, v97, v97 op_sel:[0,1] op_sel_hi:[1,0]
    v_pk_max_u16 v98, v98, v98 op_sel:[0,1] op_sel_hi:[1,0]
    v_pk_max_u16 v92, v92, v93
    v_pk_max_u16 v97, v97, v98
    s_cmp_lt_u32 s50, 4
    s_cbranch_scc1 S_loop
    v_mfma_f32_32x32x16_bf16 v[16:31], v[64:67], v[100:103], v[16:31]
    ds_read_b64_tr_b16 v[76:77], v14 offset:6144
    ds_read_b64_tr_b16 v[78:79], v14 offset:6656
    v_pk_sub_i16 v90, v90, v92
    ds_read_b128 v[136:139], v13 offset:0
    s_waitcnt lgkmcnt(6)
    v_and_b32 v80, s20, v72
    ds_read_b128 v[140:143], v13 offset:4096
    v_pk_sub_i16 v91, v91, v92
    ds_read_b128 v[144:147], v13 offset:8192
    v_and_b32_e64 v81, s20, v73
    v_pk_sub_i16 v95, v95, v97
    v_mfma_f32_32x32x16_bf16 v[32:47], v[64:67], v[104:107], v[32:47]
    v_and_b32_e64 v85, s20, v74
    v_pk_sub_i16 v96, v96, v97
    v_and_b32_e64 v86, s20, v75
    v_pk_ashrrev_i16 v90, s21, v90
    v_pk_max_u16 v82, v80, v81
    v_pk_ashrrev_i16 v91, s21, v91
    v_pk_min_u16 v83, v80, v81
    v_pk_ashrrev_i16 v95, s21, v95
    v_pk_max_u16 v87, v85, v86
    v_pk_ashrrev_i16 v96, s21, v96
    v_mfma_f32_32x32x16_bf16 v[48:63], v[64:67], v[108:111], v[48:63]
    v_pk_min_u16 v88, v85, v86
    v_bfi_b32 v68, v90, 0, v68
    v_pk_min_u16 v82, v82, v82 op_sel:[0,1] op_sel_hi:[1,0]
    v_bfi_b32 v69, v91, 0, v69
    v_pk_max_u16 v83, v83, v83 op_sel:[0,1] op_sel_hi:[1,0]
    v_bfi_b32 v70, v95, 0, v70
    v_pk_min_u16 v87, v87, v87 op_sel:[0,1] op_sel_hi:[1,0]
    v_bfi_b32 v71, v96, 0, v71
    v_pk_max_u16 v88, v88, v88 op_sel:[0,1] op_sel_hi:[1,0]
    v_pk_max_u16 v82, v82, v83
    v_pk_max_u16 v87, v87, v88
    v_mfma_f32_32x32x16_bf16 v[16:31], v[68:71], v[112:115], v[16:31]
    v_pk_sub_i16 v80, v80, v82
    s_waitcnt lgkmcnt(3)
    v_and_b32 v90, s20, v76
    v_pk_sub_i16 v81, v81, v82
    v_and_b32_e64 v91, s20, v77
    v_pk_sub_i16 v85, v85, v87
    v_and_b32_e64 v95, s20, v78
    v_pk_sub_i16 v86, v86, v87
    v_and_b32_e64 v96, s20, v79
    v_pk_ashrrev_i16 v80, s21, v80
    v_pk_max_u16 v92, v90, v91
    v_pk_ashrrev_i16 v81, s21, v81
    v_pk_min_u16 v93, v90, v91
    v_pk_ashrrev_i16 v85, s21, v85
    v_mfma_f32_32x32x16_bf16 v[32:47], v[68:71], v[116:119], v[32:47]
    v_pk_max_u16 v97, v95, v96
    v_pk_ashrrev_i16 v86, s21, v86
    v_pk_min_u16 v98, v95, v96
    v_bfi_b32 v72, v80, 0, v72
    v_pk_min_u16 v92, v92, v92 op_sel:[0,1] op_sel_hi:[1,0]
    v_bfi_b32 v73, v81, 0, v73
    v_pk_max_u16 v93, v93, v93 op_sel:[0,1] op_sel_hi:[1,0]
    v_bfi_b32 v74, v85, 0, v74
    v_pk_min_u16 v97, v97, v97 op_sel:[0,1] op_sel_hi:[1,0]
    v_bfi_b32 v75, v86, 0, v75
    v_pk_max_u16 v98, v98, v98 op_sel:[0,1] op_sel_hi:[1,0]
    v_pk_max_u16 v92, v92, v93
    v_pk_max_u16 v97, v97, v98
    v_mfma_f32_32x32x16_bf16 v[16:31], v[72:75], v[124:127], v[16:31]
    v_pk_sub_i16 v90, v90, v92
    v_pk_sub_i16 v91, v91, v92
    v_pk_sub_i16 v95, v95, v97
    v_pk_sub_i16 v96, v96, v97
    v_pk_ashrrev_i16 v90, s21, v90
    v_pk_ashrrev_i16 v91, s21, v91
    v_mfma_f32_32x32x16_bf16 v[32:47], v[72:75], v[128:131], v[32:47]
    v_pk_ashrrev_i16 v95, s21, v95
    v_pk_ashrrev_i16 v96, s21, v96
    v_bfi_b32 v76, v90, 0, v76
    v_bfi_b32 v77, v91, 0, v77
    v_bfi_b32 v78, v95, 0, v78
    v_bfi_b32 v79, v96, 0, v79
    s_nop 1
    s_waitcnt lgkmcnt(2)
    v_mfma_f32_32x32x16_bf16 v[16:31], v[76:79], v[136:139], v[16:31]
    s_waitcnt lgkmcnt(1)
    v_mfma_f32_32x32x16_bf16 v[32:47], v[76:79], v[140:143], v[32:47]
    v_mfma_f32_32x32x16_bf16 v[48:63], v[68:71], v[120:123], v[48:63]
    s_nop 7
    s_nop 3
    s_waitcnt lgkmcnt(0)
    v_cvt_pk_bf16_f32 v80, v16, v17
    v_cvt_pk_bf16_f32 v81, v18, v19
    v_cvt_pk_bf16_f32 v82, v20, v21
    v_cvt_pk_bf16_f32 v83, v22, v23
    ds_write_b64 v8, v[80:81] offset:0
    v_cvt_pk_bf16_f32 v84, v24, v25
    v_cvt_pk_bf16_f32 v85, v26, v27
    ds_write_b64 v9, v[82:83] offset:0
    v_cvt_pk_bf16_f32 v86, v28, v29
    v_cvt_pk_bf16_f32 v87, v30, v31
    ds_write_b64 v1, v[84:85] offset:0
    ds_write_b64 v15, v[86:87] offset:0
    v_mfma_f32_32x32x16_bf16 v[48:63], v[72:75], v[132:135], v[48:63]
    v_cvt_pk_bf16_f32 v88, v32, v33
    v_cvt_pk_bf16_f32 v89, v34, v35
    v_cvt_pk_bf16_f32 v90, v36, v37
    v_cvt_pk_bf16_f32 v91, v38, v39
    ds_write_b64 v8, v[88:89] offset:4096
    v_cvt_pk_bf16_f32 v92, v40, v41
    v_cvt_pk_bf16_f32 v93, v42, v43
    ds_write_b64 v9, v[90:91] offset:4096
    v_cvt_pk_bf16_f32 v94, v44, v45
    v_cvt_pk_bf16_f32 v95, v46, v47
    ds_write_b64 v1, v[92:93] offset:4096
    ds_write_b64 v15, v[94:95] offset:4096
    v_mfma_f32_32x32x16_bf16 v[48:63], v[76:79], v[144:147], v[48:63]
    s_waitcnt lgkmcnt(0)
    s_barrier
    s_nop 7
    v_cvt_pk_bf16_f32 v80, v48, v49
    v_cvt_pk_bf16_f32 v81, v50, v51
    v_cvt_pk_bf16_f32 v82, v52, v53
    v_cvt_pk_bf16_f32 v83, v54, v55
    ds_write_b64 v8, v[80:81] offset:8192
    v_cvt_pk_bf16_f32 v84, v56, v57
    v_cvt_pk_bf16_f32 v85, v58, v59
    ds_write_b64 v9, v[82:83] offset:8192
    v_cvt_pk_bf16_f32 v86, v60, v61
    v_cvt_pk_bf16_f32 v87, v62, v63
    ds_write_b64 v1, v[84:85] offset:8192
    ds_write_b64 v15, v[86:87] offset:8192
    s_waitcnt lgkmcnt(0)
S_outB:
    s_barrier
    ds_read_b128 v[16:19], v5 offset:8192
    s_add_u32 s43, s44, 73728
    s_waitcnt lgkmcnt(0)
    buffer_store_dwordx4 v[16:19], v6, s[16:19], s43 offen sc0 sc1
    s_endpgm
S_outA:
    v_lshrrev_b32 v7, 3, v2
    s_mul_i32 s44, s37, 8
    s_lshr_b32 s45, s37, 2
    s_mul_i32 s45, s45, 96
    s_add_u32 s44, s44, s45
    v_add_u32 v7, s44, v7
    v_and_b32 v1, 7, v2
    v_and_b32 v15, 7, v7
    v_xor_b32_e64 v15, v15, v1
    v_mul_u32_u24 v3, 128, v7
    v_lshl_add_u32 v3, v15, 4, v3
    v_add_u32 v3, 32768, v3
    v_mul_u32_u24 v4, 1152, v7
    v_lshl_add_u32 v4, v1, 4, v4
    s_add_u32 s44, s39, s35
    v_lshrrev_b32 v7, 3, v2
    s_mul_i32 s44, s37, 8
    s_lshr_b32 s45, s38, 2
    s_mul_i32 s45, s45, 96
    s_add_u32 s44, s44, s45
    v_add_u32 v7, s44, v7
    v_and_b32 v1, 7, v2
    v_and_b32 v15, 7, v7
    v_xor_b32_e64 v15, v15, v1
    v_mul_u32_u24 v5, 128, v7
    v_lshl_add_u32 v5, v15, 4, v5
    v_add_u32 v5, 32768, v5
    v_mul_u32_u24 v6, 1152, v7
    v_lshl_add_u32 v6, v1, 4, v6
    s_add_u32 s44, s39, s35
    s_mov_b32 s16, s10
    s_mov_b32 s17, s11
    s_mov_b32 s18, 9437184
    s_mov_b32 s19, 0x00020000
    s_barrier
    ds_read_b128 v[32:35], v3 offset:0
    ds_read_b128 v[36:39], v3 offset:4096
    ds_read_b128 v[40:43], v3 offset:12288
    ds_read_b128 v[44:47], v3 offset:16384
    s_add_u32 s43, s44, 0
    s_waitcnt lgkmcnt(3)
    buffer_store_dwordx4 v[32:35], v4, s[16:19], s43 offen sc0 sc1
    s_add_u32 s43, s44, 36864
    s_waitcnt lgkmcnt(2)
    buffer_store_dwordx4 v[36:39], v4, s[16:19], s43 offen sc0 sc1
    s_add_u32 s43, s44, 110592
    s_waitcnt lgkmcnt(1)
    buffer_store_dwordx4 v[40:43], v4, s[16:19], s43 offen sc0 sc1
    s_add_u32 s43, s44, 147456
    s_waitcnt lgkmcnt(0)
    buffer_store_dwordx4 v[44:47], v4, s[16:19], s43 offen sc0 sc1
    s_branch S_outB
L_end:
    s_endpgm
.section .rodata,"a"
.p2align 6
.amdhsa_kernel standalone__structured_sparse_n_m__ragged_kernel
  .amdhsa_next_free_vgpr 212
  .amdhsa_next_free_sgpr 96
  .amdhsa_accum_offset 212
  .amdhsa_group_segment_fixed_size 0
  .amdhsa_kernarg_size 48
  .amdhsa_user_sgpr_count 2
  .amdhsa_user_sgpr_kernarg_segment_ptr 1
  .amdhsa_system_sgpr_workgroup_id_x 1
.end_amdhsa_kernel
```
